```python
import torch

def _softmax(x, axis=-1):
    return torch.softmax(x, dim=axis)
def _gelu(x):
    return torch.nn.functional.gelu(x, approximate="tanh")
def _silu(x):
    return torch.nn.functional.silu(x)
def _sigmoid(x):
    return torch.sigmoid(x)
def _layernorm(x, axis=-1, eps=1e-5):
    m = x.mean(dim=axis, keepdim=True)
    v = x.var(dim=axis, keepdim=True, unbiased=False)
    return (x - m) / torch.sqrt(v + eps)
def _scatter_add(tgt, idx, src, axis=0):
    return tgt.clone().index_add_(axis, idx, src)
def _segment_sum(src, seg, n):
    out = torch.zeros((n,) + src.shape[1:], dtype=src.dtype)
    return out.index_add_(0, seg, src)
def _pad(x, pw):
    flat = tuple(v for pair in reversed(pw) for v in pair)
    return torch.nn.functional.pad(x, flat)

kernel_name = 'standalone__paged_block_table_kv_pagedattention__prompt'

def setup_inputs():

    _w = (lambda a: (lambda t: t.to(torch.bfloat16) if t.is_floating_point() else t)(torch.as_tensor(a)))
    B, Hq, Hkv, Sq, Skv, D = 1, 32, 32, 2048, 2048, 128
    bs = 16
    nbps = max(1, Skv // bs)
    num_phys = B * nbps + 4
    bt = torch.randperm(num_phys)[: B * nbps].reshape(B, nbps).to(torch.int64)
    cl = (nbps * bs - (torch.arange(1, B + 1, dtype=torch.int64) * 2654435761) % max(1, nbps * bs // 2)).to(torch.int64)
    return {
        "q": _w((lambda *s: torch.randn(*s, dtype=torch.bfloat16) * 0.8)(B, Hq, Sq, D)),
        "k_cache": _w((lambda *s: torch.randn(*s, dtype=torch.bfloat16) * 0.8)(num_phys, bs, Hkv, D)),
        "v_cache": _w((lambda *s: torch.randn(*s, dtype=torch.bfloat16) * 0.05)(num_phys, bs, Hkv, D)),
        "block_table": _w(bt),
        "context_lens": _w(cl),
    }

def reference(q, k_cache, v_cache, block_table, context_lens):
    B, Hq, Sq, D = q.shape
    bs = k_cache.shape[1]
    Hkv = k_cache.shape[2]
    nbps = block_table.shape[1]
    Skv = nbps * bs
    bt = block_table.reshape(-1)
    k = (lambda x, *d: x.permute(*d))(k_cache[bt].reshape(B, Skv, Hkv, D), 0, 2, 1, 3)
    v = (lambda x, *d: x.permute(*d))(v_cache[bt].reshape(B, Skv, Hkv, D), 0, 2, 1, 3)
    g = Hq // Hkv
    qg = q.reshape(B, Hkv, g, Sq, D)
    scores = torch.einsum("bhgqd,bhkd->bhgqk", qg, k) * (D ** -0.5)
    pos = torch.arange(Skv)
    msk = pos[None, :] < context_lens[:, None]
    scores = torch.where(msk[:, None, None, None, :], scores, -1e9)
    p = _softmax(scores, axis=-1)
    out = torch.einsum("bhgqk,bhkd->bhgqd", p, v)
    return out.reshape(B, Hq, Sq, D)
```

```asm
; @launch grid=(256,1,1) block=(256,1,1) lds=163840
.amdgcn_target "amdgcn-amd-amdhsa--gfx950"
.text
.globl standalone__paged_block_table_kv_pagedattention__prompt_kernel
.p2align 8
.type standalone__paged_block_table_kv_pagedattention__prompt_kernel,@function
standalone__paged_block_table_kv_pagedattention__prompt_kernel:
  s_cmpk_ge_u32 s2, 256
  s_cbranch_scc1 L_end
  s_load_dwordx2 s[20:21], s[0:1], 0
  s_load_dwordx16 s[4:19], s[0:1], 0
  s_cmp_ge_u32 s2, 8
  s_cbranch_scc1 L_nopf
  s_getpc_b64 s[98:99]
L_pc:
  v_mul_u32_u24 v1, 72, v0
  v_add_u32 v1, L_pf-L_pc, v1
  global_load_dword v47, v1, s[98:99]
L_nopf:
  v_readfirstlane_b32 s44, v0
  v_and_b32 v25, 63, v0
  v_lshrrev_b32 v2, 4, v25
  v_xor_b32 v3, v25, v2
  v_lshlrev_b32 v16, 4, v3
  v_xor_b32 v17, 64, v16
  v_xor_b32 v18, 0x80, v16
  v_xor_b32 v19, 64, v18
  s_lshr_b32 s58, s2, 3
  s_and_b32 s45, s58, 24
  s_add_u32 s45, s45, s58
  s_andn2_b32 s52, 1, s2
  s_lshl3_add_u32 s45, s52, s45
  s_and_b32 s52, s2, 6
  s_lshl_b32 s52, s52, 5
  s_add_u32 s45, s45, s52
  s_lshl_b32 s60, s45, 16
  s_lshl_b32 s55, s44, 6
  s_add_u32 s60, s60, s55
  s_add_u32 m0, s55, 98304
  s_lshr_b32 s59, s44, 4
  s_lshl_b32 s22, 1, 24
  s_mov_b32 s23, 0x20000
  s_bfe_u32 s52, s44, 0x10006
  s_lshl1_add_u32 s58, s58, s52
  s_mul_i32 s58, s58, 270336
  s_mov_b32 s53, -1
  s_cmp_lt_u32 s59, 8
  s_waitcnt lgkmcnt(0)
  s_load_dword s53, s[10:11], s59
  s_cselect_b64 s[24:25], s[6:7], s[8:9]
  s_load_dword s52, s[24:25], s58
  buffer_load_dwordx4 v16, s[20:23], s60 offen offset:0 nt lds
  buffer_load_dwordx4 v17, s[20:23], s60 offen offset:1024 nt lds
  buffer_load_dwordx4 v18, s[20:23], s60 offen offset:2048 nt lds
  buffer_load_dwordx4 v19, s[20:23], s60 offen offset:3072 nt lds
  s_branch L_pf
L_e256:
.p2align 12
.fill 794, 4, 0xbf800000
L_pf:
  s_lshr_b32 s45, s45, 3
  s_lshl_b32 s45, s45, 8
  v_and_b32 v3, 15, v25
  v_lshl_add_u32 v4, v2, 13, s45
  v_lshl_add_u32 v28, v3, 4, v4
  s_mul_i32 s32, s59, 1096
  s_add_u32 m0, s32, 8768
  s_mov_b64 s[36:37], s[6:7]
  s_mov_b32 s38, 17301504
  s_mov_b32 s39, 0x20000
  v_add_u32 v29, 31680, v28
  v_add_u32 v30, 63360, v28
  v_add_u32 v31, 95040, v28
  v_bfe_u32 v1, v0, 6, 1
  v_lshl_add_u32 v1, v25, 1, v1
  v_lshlrev_b32 v1, 2, v1
  global_load_dword v32, v1, s[10:11]
  s_add_u32 s55, s55, 98304
  s_xor_b32 s61, s60, 16384
  s_waitcnt lgkmcnt(1)
  s_cmp_lg_u32 s53, -1
  s_cbranch_scc1 L_gotpg
  s_waitcnt lgkmcnt(0)
L_gotpg:
  s_lshl_b32 s53, s53, 17
  s_load_dword s47, s[12:13], 0
  buffer_load_dwordx4 v28, s[36:39], s53 offen offset:0 lds
  buffer_load_dwordx4 v29, s[36:39], s53 offen offset:1088 lds
  buffer_load_dwordx4 v30, s[36:39], s53 offen offset:2176 lds
  buffer_load_dwordx4 v31, s[36:39], s53 offen offset:3264 lds
  s_add_u32 m0, s55, 16384
  s_nop 0
  buffer_load_dwordx4 v16, s[20:23], s61 offen offset:0 nt lds
  buffer_load_dwordx4 v17, s[20:23], s61 offen offset:1024 nt lds
  buffer_load_dwordx4 v18, s[20:23], s61 offen offset:2048 nt lds
  buffer_load_dwordx4 v19, s[20:23], s61 offen offset:3072 nt lds
  s_lshr_b32 s44, s44, 6
  s_xor_b32 s62, s60, 32768
  s_xor_b32 s63, s60, 49152
  s_mov_b32 s40, s8
  s_mov_b32 s41, s9
  s_mov_b32 s42, 17301504
  s_mov_b32 s43, 0x20000
  s_mov_b32 s26, 17301504
  s_mov_b32 s27, 0x20000
  s_mov_b32 s28, s14
  s_mov_b32 s29, s15
  s_mov_b32 s30, 16777216
  s_mov_b32 s31, 0x20000
  s_mov_b32 s51, s32
  s_and_b32 s58, s44, 1
  s_mul_i32 s58, s58, 24
  s_sub_u32 s32, s32, s58
  s_add_u32 s58, s32, 43840
  s_cmp_lt_u32 s44, 2
  s_cselect_b32 s51, s51, s58
  v_and_b32 v4, 7, v3
  v_lshrrev_b32 v5, 3, v3
  v_mul_u32_u24 v6, 1088, v4
  v_lshl_add_u32 v6, v5, 8, v6
  v_lshrrev_b32 v4, 2, v4
  v_lshl_add_u32 v6, v4, 5, v6
  v_lshl_add_u32 v27, v2, 4, v6
  v_and_b32 v7, 1, v2
  v_lshrrev_b32 v8, 1, v2
  v_lshlrev_b32 v6, 8, v3
  v_lshl_add_u32 v24, v2, 4, v6
  v_lshl_add_u32 v23, v7, 4, v8
  v_bfe_u32 v4, v25, 2, 3
  v_mul_u32_u24 v6, 1088, v4
  v_lshl_add_u32 v6, v8, 8, v6
  v_lshl_add_u32 v6, v7, 3, v6
  v_and_b32 v4, 3, v25
  v_lshl_add_u32 v6, v4, 4, v6
  v_add_u32 v26, 52608, v6
  v_lshrrev_b32 v5, 2, v3
  v_mul_u32_u24 v6, 1088, v4
  v_lshl_add_u32 v6, v5, 8, v6
  v_lshl_add_u32 v21, v2, 4, v6
  v_mul_u32_u24 v6, 1088, v5
  v_lshl_add_u32 v6, v2, 8, v6
  v_lshl_add_u32 v6, v4, 4, v6
  v_add_u32 v20, 52608, v6
  v_bfe_u32 v4, v25, 1, 1
  v_cmp_eq_u32 vcc, v4, v8
  v_mov_b32 v5, 0x3f803f80
  v_and_b32 v4, 1, v25
  v_cndmask_b32 v36, 0, v5, vcc
  v_cndmask_b32 v37, 0, v5, vcc
  v_cndmask_b32 v38, 0, v5, vcc
  v_cndmask_b32 v39, 0, v5, vcc
  v_mul_u32_u24 v4, 0xaaaa, v4
  v_add_u32 v35, 0x4444, v4
  v_lshrrev_b32 v4, 2, v3
  v_cmp_eq_u32 s[98:99], v4, v2
  v_and_b32 v4, 3, v3
  v_mul_u32_u24 v22, 0x55, v4
  v_mov_b32 v13, 0
  v_mov_b32 v14, 0
  v_xor_b32 v4, v2, v3
  v_lshlrev_b32 v4, 4, v4
  v_lshl_add_u32 v4, v3, 8, v4
  v_add_u32 v4, s55, v4
  v_xor_b32 v5, 64, v4
  v_xor_b32 v6, 0x80, v4
  v_xor_b32 v7, 64, v6
  v_mov_b64 v[128:129], 0
  v_mov_b64 v[130:131], 0
  v_mov_b64 v[132:133], 0
  v_mov_b64 v[134:135], 0
  v_mov_b64 v[136:137], 0
  v_mov_b64 v[138:139], 0
  v_mov_b64 v[140:141], 0
  v_mov_b64 v[142:143], 0
  v_mov_b64 v[144:145], 0
  v_mov_b64 v[146:147], 0
  v_mov_b64 v[148:149], 0
  v_mov_b64 v[150:151], 0
  v_mov_b64 v[152:153], 0
  v_mov_b64 v[154:155], 0
  v_mov_b64 v[156:157], 0
  v_mov_b64 v[158:159], 0
  v_mov_b64 v[160:161], 0
  v_mov_b64 v[162:163], 0
  v_mov_b64 v[164:165], 0
  v_mov_b64 v[166:167], 0
  v_mov_b64 v[168:169], 0
  v_mov_b64 v[170:171], 0
  v_mov_b64 v[172:173], 0
  v_mov_b64 v[174:175], 0
  v_mov_b64 v[176:177], 0
  v_mov_b64 v[178:179], 0
  v_mov_b64 v[180:181], 0
  v_mov_b64 v[182:183], 0
  v_mov_b64 v[184:185], 0
  v_mov_b64 v[186:187], 0
  v_mov_b64 v[188:189], 0
  v_mov_b64 v[190:191], 0
  v_mov_b64 v[192:193], 0
  v_mov_b64 v[194:195], 0
  v_mov_b64 v[196:197], 0
  v_mov_b64 v[198:199], 0
  v_mov_b64 v[200:201], 0
  v_mov_b64 v[202:203], 0
  v_mov_b64 v[204:205], 0
  v_mov_b64 v[206:207], 0
  v_mov_b64 v[208:209], 0
  v_mov_b64 v[210:211], 0
  v_mov_b64 v[212:213], 0
  v_mov_b64 v[214:215], 0
  v_mov_b64 v[216:217], 0
  v_mov_b64 v[218:219], 0
  v_mov_b64 v[220:221], 0
  v_mov_b64 v[222:223], 0
  v_mov_b64 v[224:225], 0
  v_mov_b64 v[226:227], 0
  v_mov_b64 v[228:229], 0
  v_mov_b64 v[230:231], 0
  v_mov_b64 v[232:233], 0
  v_mov_b64 v[234:235], 0
  v_mov_b64 v[236:237], 0
  v_mov_b64 v[238:239], 0
  v_mov_b64 v[240:241], 0
  v_mov_b64 v[242:243], 0
  v_mov_b64 v[244:245], 0
  v_mov_b64 v[246:247], 0
  v_mov_b64 v[248:249], 0
  v_mov_b64 v[250:251], 0
  v_mov_b64 v[252:253], 0
  v_mov_b64 v[254:255], 0
  v_mov_b64 v[80:81], 0
  v_mov_b64 v[82:83], 0
  v_mov_b64 v[84:85], 0
  v_mov_b64 v[86:87], 0
  v_mov_b64 v[88:89], 0
  v_mov_b64 v[90:91], 0
  v_mov_b64 v[92:93], 0
  v_mov_b64 v[94:95], 0
  v_mov_b32 v34, v27
  v_add_u32 v33, 35072, v26
  s_mov_b32 s50, 0
  s_mov_b32 s34, 0xc2280000
  s_mov_b32 s35, s34
  s_movk_i32 s100, 17536
  s_mov_b32 s101, 52608
  s_mov_b64 vcc, -1
  s_cmp_eq_u32 s44, 0
  s_cbranch_scc1 L_st0
  s_cmp_eq_u32 s44, 1
  s_cbranch_scc1 L_st1
  s_cmp_eq_u32 s44, 2
  s_cbranch_scc1 L_st2
  s_branch L_st3
L_stret:
  s_mov_b64 vcc, 0
  s_waitcnt lgkmcnt(0)
  s_mov_b32 s56, 0x3e0293ee
  s_cmp_lt_i32 s47, 1
  s_cselect_b32 s56, 0, s56
  s_cselect_b32 s47, 2048, s47
  s_min_u32 s47, s47, 2048
  s_sub_u32 s48, s47, 1
  s_lshr_b32 s48, s48, 5
  s_mov_b32 s57, s56
  s_cmp_lt_u32 s48, 5
  s_cbranch_scc1 L_slow0
  s_cmp_eq_u32 s56, 0
  s_cselect_b32 s58, 0, 0xb9d83e03
  v_mov_b32 v1, s58
  v_cndmask_b32 v12, 0, v1, s[98:99]
  v_cndmask_b32 v15, 0, v1, s[98:99]
  s_waitcnt vmcnt(8)
  s_cmp_lt_u32 s44, 2
  s_cselect_b32 s52, 2, 0
  s_cselect_b32 s59, 17536, 0
  v_lshlrev_b32 v32, 17, v32
  s_add_u32 s59, s59, s51
  v_readlane_b32 s53, v32, s52
  ds_read_b128 a[0:3], v4 offset:0
  ds_read_b128 a[4:7], v5 offset:0
  ds_read_b128 a[8:11], v6 offset:0
  ds_read_b128 a[12:15], v7 offset:0
  v_lshrrev_b32 v1, 4, v25
  s_add_u32 m0, s59, 8768
  s_lshl_b32 s58, s48, 5
  buffer_load_dwordx4 v28, s[24:27], s53 offen offset:0 lds
  s_sub_u32 s54, s47, s58
  s_sub_u32 s49, s48, 3
  s_lshr_b32 s49, s49, 1
  s_and_b32 s46, s48, 1
  s_cmp_gt_u32 s54, 16
  s_cselect_b32 s58, 2, 0
  s_or_b32 s46, s46, s58
  s_cmp_lt_u32 s48, 8
  s_cselect_b32 s58, 2, 0
  s_or_b32 s46, s46, s58
  s_cselect_b32 s58, 0, 1
  s_sub_u32 s49, s49, s58
  v_sub_u32 v1, s54, v1
  buffer_load_dwordx4 v29, s[24:27], s53 offen offset:1088 lds
  v_add_u32 v8, -1, v1
  s_waitcnt lgkmcnt(3)
  v_smfmac_f32_16x16x32_bf16 v[128:131], v[12:13], a[0:3], v22
  v_add_u32 v9, -5, v1
  v_add_u32 v10, -9, v1
  v_smfmac_f32_16x16x32_bf16 v[132:135], v[14:15], a[0:3], v22
  s_waitcnt lgkmcnt(2)
  v_add_u32 v11, -13, v1
  v_ashrrev_i32 v8, 31, v8
  v_smfmac_f32_16x16x32_bf16 v[136:139], v[12:13], a[4:7], v22
  s_waitcnt lgkmcnt(1)
  v_and_b32 v8, 0xff800000, v8
  v_ashrrev_i32 v9, 31, v9
  v_smfmac_f32_16x16x32_bf16 v[140:143], v[14:15], a[4:7], v22
  buffer_load_dwordx4 v30, s[24:27], s53 offen offset:2176 lds
  v_smfmac_f32_16x16x32_bf16 v[144:147], v[12:13], a[8:11], v22
  v_cvt_pk_bf16_f32 v128, v128, v129
  v_cvt_pk_bf16_f32 v130, v130, v131
  v_smfmac_f32_16x16x32_bf16 v[148:151], v[14:15], a[8:11], v22
  s_waitcnt lgkmcnt(0)
  v_cvt_pk_bf16_f32 v132, v132, v133
  v_cvt_pk_bf16_f32 v134, v134, v135
  v_smfmac_f32_16x16x32_bf16 v[152:155], v[12:13], a[12:15], v22
  v_accvgpr_write_b32 a0, v128
  v_accvgpr_write_b32 a1, v130
  v_smfmac_f32_16x16x32_bf16 v[156:159], v[14:15], a[12:15], v22
  buffer_load_dwordx4 v31, s[24:27], s53 offen offset:3264 lds
  v_accvgpr_write_b32 a2, v132
  v_accvgpr_write_b32 a3, v134
  v_cvt_pk_bf16_f32 v136, v136, v137
  v_cvt_pk_bf16_f32 v138, v138, v139
  v_cvt_pk_bf16_f32 v140, v140, v141
  v_cvt_pk_bf16_f32 v142, v142, v143
  v_accvgpr_write_b32 a4, v136
  v_accvgpr_write_b32 a5, v138
  v_accvgpr_write_b32 a6, v140
  v_accvgpr_write_b32 a7, v142
  v_cvt_pk_bf16_f32 v144, v144, v145
  v_cvt_pk_bf16_f32 v146, v146, v147
  v_cvt_pk_bf16_f32 v148, v148, v149
  v_cvt_pk_bf16_f32 v150, v150, v151
  v_accvgpr_write_b32 a8, v144
  v_accvgpr_write_b32 a9, v146
  v_accvgpr_write_b32 a10, v148
  v_accvgpr_write_b32 a11, v150
  v_cvt_pk_bf16_f32 v152, v152, v153
  v_cvt_pk_bf16_f32 v154, v154, v155
  v_cvt_pk_bf16_f32 v156, v156, v157
  v_cvt_pk_bf16_f32 v158, v158, v159
  v_accvgpr_write_b32 a12, v152
  v_accvgpr_write_b32 a13, v154
  v_accvgpr_write_b32 a14, v156
  v_accvgpr_write_b32 a15, v158
  v_and_b32 v9, 0xff800000, v9
  v_ashrrev_i32 v10, 31, v10
  v_and_b32 v10, 0xff800000, v10
  v_ashrrev_i32 v11, 31, v11
  v_and_b32 v11, 0xff800000, v11
  s_waitcnt vmcnt(8)
  s_add_u32 m0, s55, 32768
  s_nop 0
  buffer_load_dwordx4 v16, s[20:23], s62 offen offset:0 nt lds
  s_barrier
  ds_read_b128 a[64:67], v27 offset:8768
  ds_read_b128 a[80:83], v27 offset:9280
  ds_read_b128 a[68:71], v27 offset:8832
  ds_read_b128 a[84:87], v27 offset:9344
  ds_read_b128 a[72:75], v27 offset:8896
  buffer_load_dwordx4 v17, s[20:23], s62 offen offset:1024 nt lds
  ds_read_b128 a[88:91], v27 offset:9408
  ds_read_b128 a[76:79], v27 offset:8960
  ds_read_b128 a[92:95], v27 offset:9472
  ds_read_b128 a[96:99], v27 offset:17536
  buffer_load_dwordx4 v18, s[20:23], s62 offen offset:2048 nt lds
  ds_read_b128 a[100:103], v27 offset:17600
  s_waitcnt lgkmcnt(9)
  v_mfma_f32_16x16x32_bf16 v[128:131], a[64:67], a[0:3], 0
  s_waitcnt lgkmcnt(8)
  ds_read_b128 a[104:107], v27 offset:17664
  v_mfma_f32_16x16x32_bf16 v[132:135], a[80:83], a[0:3], 0
  s_waitcnt lgkmcnt(8)
  ds_read_b128 a[108:111], v27 offset:17728
  v_mfma_f32_16x16x32_bf16 v[128:131], a[68:71], a[4:7], v[128:131]
  s_waitcnt lgkmcnt(8)
  ds_read_b128 a[124:127], v27 offset:18240
  v_mfma_f32_16x16x32_bf16 v[132:135], a[84:87], a[4:7], v[132:135]
  s_waitcnt lgkmcnt(8)
  buffer_load_dwordx4 v19, s[20:23], s62 offen offset:3072 nt lds
  v_mfma_f32_16x16x32_bf16 v[128:131], a[72:75], a[8:11], v[128:131]
  s_waitcnt lgkmcnt(7)
  ds_read_b128 a[120:123], v27 offset:18176
  ds_read_b128 a[116:119], v27 offset:18112
  v_mfma_f32_16x16x32_bf16 v[132:135], a[88:91], a[8:11], v[132:135]
  s_waitcnt lgkmcnt(8)
  v_mfma_f32_16x16x32_bf16 v[128:131], a[76:79], a[12:15], v[128:131]
  s_waitcnt lgkmcnt(7)
  ds_read_b128 a[112:115], v27 offset:18048
  v_mfma_f32_16x16x32_bf16 v[132:135], a[92:95], a[12:15], v[132:135]
  s_nop 4
  v_max3_f32 v0, v128, v129, v130
  s_nop 1
  v_max3_f32 v1, v131, v132, v133
  v_max3_f32 v0, v0, v134, v135
  v_max_f32 v0, v0, v1
  v_mov_b32 v1, v0
  s_nop 1
  v_permlane32_swap_b32 v0, v1
  v_max_f32 v0, v0, v1
  v_mov_b32 v1, v0
  s_nop 1
  v_permlane16_swap_b32 v0, v1
  v_max_f32 v0, v0, v1
  v_pk_add_f32 v[48:49], s[34:35], v[0:1] op_sel_hi:[1,0] neg_lo:[0,1] neg_hi:[0,1]
  v_pk_add_f32 v[50:51], s[34:35], v[0:1] op_sel_hi:[1,0] neg_lo:[0,1] neg_hi:[0,1]
  v_pk_add_f32 v[128:129], v[128:129], v[48:49]
  v_pk_add_f32 v[130:131], v[130:131], v[48:49]
  v_pk_add_f32 v[132:133], v[132:133], v[48:49]
  v_pk_add_f32 v[134:135], v[134:135], v[48:49]
  s_waitcnt lgkmcnt(2)
  v_mfma_f32_16x16x32_bf16 v[96:99], a[96:99], a[0:3], v[48:51]
  v_exp_f32 v128, v128
  v_mfma_f32_16x16x32_bf16 v[96:99], a[100:103], a[4:7], v[96:99]
  v_exp_f32 v129, v129
  v_mfma_f32_16x16x32_bf16 v[96:99], a[104:107], a[8:11], v[96:99]
  v_exp_f32 v130, v130
  v_mfma_f32_16x16x32_bf16 v[96:99], a[108:111], a[12:15], v[96:99]
  s_waitcnt lgkmcnt(0)
  v_exp_f32 v131, v131
  v_mfma_f32_16x16x32_bf16 v[100:103], a[124:127], a[12:15], v[48:51]
  s_waitcnt vmcnt(8)
  s_cmp_lt_u32 s44, 2
  v_mfma_f32_16x16x32_bf16 v[100:103], a[120:123], a[8:11], v[100:103]
  s_cselect_b32 s52, 1, 2
  v_readlane_b32 s53, v32, s52
  v_mfma_f32_16x16x32_bf16 v[100:103], a[116:119], a[4:7], v[100:103]
  ds_read_b128 a[16:19], v4 offset:16384
  ds_read_b128 a[20:23], v5 offset:16384
  v_mfma_f32_16x16x32_bf16 v[100:103], a[112:115], a[0:3], v[100:103]
  v_exp_f32 v132, v132
  s_add_u32 m0, s32, 70144
  ds_read_b128 a[24:27], v6 offset:16384
  buffer_load_dwordx4 v28, s[40:43], s53 offen offset:0 lds
  ds_read_b128 a[28:31], v7 offset:16384
  v_exp_f32 v133, v133
  v_exp_f32 v134, v134
  v_exp_f32 v135, v135
  v_cvt_pk_bf16_f32 v40, v128, v129
  v_cvt_pk_bf16_f32 v41, v130, v131
  v_cvt_pk_bf16_f32 v42, v132, v133
  v_cvt_pk_bf16_f32 v43, v134, v135
  v_exp_f32 v96, v96
  buffer_load_dwordx4 v29, s[40:43], s53 offen offset:1088 lds
  s_mov_b32 s52, 7
  s_waitcnt lgkmcnt(3)
  v_smfmac_f32_16x16x32_bf16 v[160:163], v[12:13], a[16:19], v22
  v_exp_f32 v97, v97
  v_smfmac_f32_16x16x32_bf16 v[164:167], v[14:15], a[16:19], v22
  s_waitcnt lgkmcnt(2)
  v_exp_f32 v98, v98
  v_smfmac_f32_16x16x32_bf16 v[168:171], v[12:13], a[20:23], v22
  s_waitcnt lgkmcnt(1)
  v_exp_f32 v99, v99
  v_smfmac_f32_16x16x32_bf16 v[172:175], v[14:15], a[20:23], v22
  buffer_load_dwordx4 v30, s[40:43], s53 offen offset:2176 lds
  v_smfmac_f32_16x16x32_bf16 v[176:179], v[12:13], a[24:27], v22
  v_cvt_pk_bf16_f32 v160, v160, v161
  v_cvt_pk_bf16_f32 v162, v162, v163
  v_smfmac_f32_16x16x32_bf16 v[180:183], v[14:15], a[24:27], v22
  s_waitcnt lgkmcnt(0)
  v_cvt_pk_bf16_f32 v164, v164, v165
  v_cvt_pk_bf16_f32 v166, v166, v167
  v_smfmac_f32_16x16x32_bf16 v[184:187], v[12:13], a[28:31], v22
  v_accvgpr_write_b32 a16, v160
  v_accvgpr_write_b32 a17, v162
  v_smfmac_f32_16x16x32_bf16 v[188:191], v[14:15], a[28:31], v22
  buffer_load_dwordx4 v31, s[40:43], s53 offen offset:3264 lds
  v_accvgpr_write_b32 a18, v164
  v_accvgpr_write_b32 a19, v166
  v_cvt_pk_bf16_f32 v168, v168, v169
  v_cvt_pk_bf16_f32 v170, v170, v171
  v_mfma_f32_16x16x32_bf16 v[160:163], a[64:67], a[16:19], 0
  v_cvt_pk_bf16_f32 v172, v172, v173
  v_cvt_pk_bf16_f32 v174, v174, v175
  v_mfma_f32_16x16x32_bf16 v[164:167], a[80:83], a[16:19], 0
  v_accvgpr_write_b32 a20, v168
  v_accvgpr_write_b32 a21, v170
  v_accvgpr_write_b32 a22, v172
  v_accvgpr_write_b32 a23, v174
  v_cvt_pk_bf16_f32 v176, v176, v177
  v_cvt_pk_bf16_f32 v178, v178, v179
  v_mfma_f32_16x16x32_bf16 v[160:163], a[68:71], a[20:23], v[160:163]
  v_cvt_pk_bf16_f32 v180, v180, v181
  v_cvt_pk_bf16_f32 v182, v182, v183
  v_mfma_f32_16x16x32_bf16 v[164:167], a[84:87], a[20:23], v[164:167]
  v_accvgpr_write_b32 a24, v176
  v_accvgpr_write_b32 a25, v178
  v_accvgpr_write_b32 a26, v180
  v_accvgpr_write_b32 a27, v182
  v_cvt_pk_bf16_f32 v184, v184, v185
  v_cvt_pk_bf16_f32 v186, v186, v187
  v_mfma_f32_16x16x32_bf16 v[160:163], a[72:75], a[24:27], v[160:163]
  v_cvt_pk_bf16_f32 v188, v188, v189
  v_cvt_pk_bf16_f32 v190, v190, v191
  v_mfma_f32_16x16x32_bf16 v[164:167], a[88:91], a[24:27], v[164:167]
  v_accvgpr_write_b32 a28, v184
  v_accvgpr_write_b32 a29, v186
  v_accvgpr_write_b32 a30, v188
  v_accvgpr_write_b32 a31, v190
  v_exp_f32 v100, v100
  v_exp_f32 v101, v101
  v_mfma_f32_16x16x32_bf16 v[160:163], a[76:79], a[28:31], v[160:163]
  v_exp_f32 v102, v102
  v_mfma_f32_16x16x32_bf16 v[164:167], a[92:95], a[28:31], v[164:167]
  v_exp_f32 v103, v103
  v_cvt_pk_bf16_f32 v64, v96, v97
  v_cvt_pk_bf16_f32 v65, v98, v99
  v_cvt_pk_bf16_f32 v66, v100, v101
  v_cvt_pk_bf16_f32 v67, v102, v103
  s_nop 0
  v_max3_f32 v2, v160, v161, v162
  s_nop 0
  v_max3_f32 v3, v163, v164, v165
  v_max3_f32 v2, v2, v166, v167
  v_max_f32 v2, v2, v3
  v_mov_b32 v3, v2
  s_nop 1
  v_permlane32_swap_b32 v2, v3
  v_max_f32 v2, v2, v3
  v_mov_b32 v3, v2
  s_nop 1
  v_permlane16_swap_b32 v2, v3
  v_max_f32 v2, v2, v3
  v_pk_add_f32 v[52:53], s[34:35], v[2:3] op_sel_hi:[1,0] neg_lo:[0,1] neg_hi:[0,1]
  v_pk_add_f32 v[54:55], s[34:35], v[2:3] op_sel_hi:[1,0] neg_lo:[0,1] neg_hi:[0,1]
  v_pk_add_f32 v[160:161], v[160:161], v[52:53]
  v_pk_add_f32 v[162:163], v[162:163], v[52:53]
  v_pk_add_f32 v[164:165], v[164:165], v[52:53]
  v_pk_add_f32 v[166:167], v[166:167], v[52:53]
  v_mfma_f32_16x16x32_bf16 v[112:115], a[96:99], a[16:19], v[52:55]
  v_exp_f32 v160, v160
  v_mfma_f32_16x16x32_bf16 v[112:115], a[100:103], a[20:23], v[112:115]
  s_waitcnt vmcnt(8)
  s_add_u32 m0, s55, 49152
  v_mfma_f32_16x16x32_bf16 v[112:115], a[104:107], a[24:27], v[112:115]
  buffer_load_dwordx4 v16, s[20:23], s63 offen offset:0 nt lds
  v_mfma_f32_16x16x32_bf16 v[112:115], a[108:111], a[28:31], v[112:115]
  v_exp_f32 v161, v161
  v_mfma_f32_16x16x32_bf16 v[116:119], a[124:127], a[28:31], v[52:55]
  v_exp_f32 v162, v162
  v_mfma_f32_16x16x32_bf16 v[116:119], a[120:123], a[24:27], v[116:119]
  v_exp_f32 v163, v163
  v_mfma_f32_16x16x32_bf16 v[116:119], a[116:119], a[20:23], v[116:119]
  buffer_load_dwordx4 v17, s[20:23], s63 offen offset:1024 nt lds
  v_mfma_f32_16x16x32_bf16 v[116:119], a[112:115], a[16:19], v[116:119]
  s_barrier
  ds_read_b64_tr_b16 a[226:227], v26 offset:9280
  ds_read_b64_tr_b16 a[224:225], v26 offset:8768
  v_exp_f32 v164, v164
  ds_read_b128 a[192:195], v27 offset:26304
  buffer_load_dwordx4 v18, s[20:23], s63 offen offset:2048 nt lds
  ds_read_b128 a[196:199], v27 offset:26368
  ds_read_b128 a[200:203], v27 offset:26432
  ds_read_b128 a[204:207], v27 offset:26496
  ds_read_b128 a[220:223], v27 offset:27008
  v_exp_f32 v165, v165
  ds_read_b128 a[216:219], v27 offset:26944
  v_exp_f32 v166, v166
  ds_read_b128 a[212:215], v27 offset:26880
  buffer_load_dwordx4 v19, s[20:23], s63 offen offset:3072 nt lds
  ds_read_b128 a[208:211], v27 offset:26816
  ds_read_b64_tr_b16 a[230:231], v26 offset:9288
  s_waitcnt lgkmcnt(9)
  v_mfma_f32_16x16x32_bf16 v[152:155], a[224:227], v[40:43], 0
  v_exp_f32 v167, v167
  v_cvt_pk_bf16_f32 v44, v160, v161
  v_cvt_pk_bf16_f32 v45, v162, v163
  s_waitcnt lgkmcnt(8)
  v_mfma_f32_16x16x32_bf16 v[104:107], a[192:195], a[0:3], v[48:51]
  s_waitcnt lgkmcnt(7)
  ds_read_b64_tr_b16 a[228:229], v26 offset:8776
  ds_read_b64_tr_b16 a[234:235], v26 offset:9344
  v_mfma_f32_16x16x32_bf16 v[104:107], a[196:199], a[4:7], v[104:107]
  s_waitcnt lgkmcnt(8)
  v_cvt_pk_bf16_f32 v46, v164, v165
  v_cvt_pk_bf16_f32 v47, v166, v167
  v_mfma_f32_16x16x32_bf16 v[104:107], a[200:203], a[8:11], v[104:107]
  s_waitcnt lgkmcnt(7)
  ds_read_b64_tr_b16 a[232:233], v26 offset:8832
  ds_read_b64_tr_b16 a[238:239], v26 offset:9352
  v_mfma_f32_16x16x32_bf16 v[104:107], a[204:207], a[12:15], v[104:107]
  s_waitcnt lgkmcnt(8)
  v_max3_f32 v152, abs(v152), abs(v153), abs(v154)
  v_max_f32_e64 v152, v152, abs(v155)
  v_mfma_f32_16x16x32_bf16 v[108:111], a[220:223], a[12:15], v[48:51]
  s_waitcnt lgkmcnt(7)
  ds_read_b64_tr_b16 a[236:237], v26 offset:8840
  ds_read_b64_tr_b16 a[242:243], v26 offset:9408
  v_mfma_f32_16x16x32_bf16 v[108:111], a[216:219], a[8:11], v[108:111]
  s_waitcnt lgkmcnt(8)
  v_and_b32 v152, 0x7f800000, v152
  v_mul_f32 v156, 0x41800000, v152
  v_mfma_f32_16x16x32_bf16 v[108:111], a[212:215], a[4:7], v[108:111]
  s_waitcnt lgkmcnt(7)
  ds_read_b64_tr_b16 a[240:241], v26 offset:8896
  ds_read_b64_tr_b16 a[246:247], v26 offset:9416
  v_mfma_f32_16x16x32_bf16 v[108:111], a[208:211], a[0:3], v[108:111]
  v_mul_f32 v157, 0x41800000, v152
  v_mov_b64 v[158:159], v[156:157]
  v_mfma_f32_16x16x32_bf16 v[184:187], a[224:227], v[44:47], 0
  ds_read_b64_tr_b16 a[244:245], v26 offset:8904
  ds_read_b64_tr_b16 a[250:251], v26 offset:9472
  v_mfma_f32_16x16x32_bf16 v[128:131], a[224:227], v[40:43], v[156:159]
  s_waitcnt lgkmcnt(8)
  v_exp_f32 v104, v104
  v_mfma_f32_16x16x32_bf16 v[132:135], a[228:231], v[40:43], v[156:159]
  s_waitcnt lgkmcnt(6)
  ds_read_b64_tr_b16 a[248:249], v26 offset:8960
  ds_read_b64_tr_b16 a[254:255], v26 offset:9480
  v_mfma_f32_16x16x32_bf16 v[136:139], a[232:235], v[40:43], v[156:159]
  s_waitcnt lgkmcnt(7)
  v_mul_f32 v16, 0xc1800000, v152
  v_max3_f32 v184, abs(v184), abs(v185), abs(v186)
  v_mfma_f32_16x16x32_bf16 v[140:143], a[236:239], v[40:43], v[156:159]
  ds_read_b64_tr_b16 a[252:253], v26 offset:8968
  v_max_f32_e64 v184, v184, abs(v187)
  v_and_b32 v184, 0x7f800000, v184
  s_waitcnt lgkmcnt(6)
  v_mfma_f32_16x16x32_bf16 v[144:147], a[240:243], v[40:43], v[156:159]
  v_mul_f32 v188, 0x41800000, v184
  v_mul_f32 v189, 0x41800000, v184
  v_mov_b64 v[190:191], v[188:189]
  v_mul_f32 v17, 0xc1800000, v184
  v_exp_f32 v105, v105
  s_waitcnt lgkmcnt(4)
  v_mfma_f32_16x16x32_bf16 v[148:151], a[244:247], v[40:43], v[156:159]
  v_exp_f32 v106, v106
  v_exp_f32 v107, v107
  v_exp_f32 v108, v108
  s_waitcnt lgkmcnt(2)
  v_mfma_f32_16x16x32_bf16 v[152:155], a[248:251], v[40:43], v[156:159]
  v_exp_f32 v109, v109
  v_exp_f32 v110, v110
  v_exp_f32 v111, v111
  s_waitcnt lgkmcnt(0)
  v_mfma_f32_16x16x32_bf16 v[156:159], a[252:255], v[40:43], v[156:159]
  v_cvt_pk_bf16_f32 v68, v104, v105
  v_cvt_pk_bf16_f32 v69, v106, v107
  v_smfmac_f32_16x16x64_bf16 v[82:85], v[36:39], v[40:47], v35
  v_cvt_pk_bf16_f32 v70, v108, v109
  s_waitcnt vmcnt(8)
  v_mfma_f32_16x16x32_bf16 v[160:163], a[224:227], v[44:47], v[188:191]
  s_add_u32 m0, s51, 35072
  v_readlane_b32 s53, v32, 3
  v_mfma_f32_16x16x32_bf16 v[164:167], a[228:231], v[44:47], v[188:191]
  ds_read_b128 a[32:35], v4 offset:32768
  ds_read_b128 a[36:39], v5 offset:32768
  v_mfma_f32_16x16x32_bf16 v[168:171], a[232:235], v[44:47], v[188:191]
  v_exp_f32 v112, v112
  v_mfma_f32_16x16x32_bf16 v[172:175], a[236:239], v[44:47], v[188:191]
  buffer_load_dwordx4 v28, s[24:27], s53 offen offset:0 lds
  v_mfma_f32_16x16x32_bf16 v[176:179], a[240:243], v[44:47], v[188:191]
  ds_read_b128 a[40:43], v6 offset:32768
  ds_read_b128 a[44:47], v7 offset:32768
  v_mfma_f32_16x16x32_bf16 v[180:183], a[244:247], v[44:47], v[188:191]
  v_exp_f32 v113, v113
  v_mfma_f32_16x16x32_bf16 v[184:187], a[248:251], v[44:47], v[188:191]
  v_cvt_pk_bf16_f32 v71, v110, v111
  v_cvt_pk_bf16_f32 v72, v112, v113
  v_mfma_f32_16x16x32_bf16 v[188:191], a[252:255], v[44:47], v[188:191]
  buffer_load_dwordx4 v29, s[24:27], s53 offen offset:1088 lds
  v_exp_f32 v114, v114
  s_waitcnt lgkmcnt(3)
  v_smfmac_f32_16x16x32_bf16 v[192:195], v[12:13], a[32:35], v22
  v_exp_f32 v115, v115
  v_smfmac_f32_16x16x32_bf16 v[196:199], v[14:15], a[32:35], v22
  s_waitcnt lgkmcnt(2)
  v_exp_f32 v116, v116
  v_smfmac_f32_16x16x32_bf16 v[200:203], v[12:13], a[36:39], v22
  s_waitcnt lgkmcnt(1)
  v_exp_f32 v117, v117
  v_smfmac_f32_16x16x32_bf16 v[204:207], v[14:15], a[36:39], v22
  buffer_load_dwordx4 v30, s[24:27], s53 offen offset:2176 lds
  v_smfmac_f32_16x16x32_bf16 v[208:211], v[12:13], a[40:43], v22
  v_cvt_pk_bf16_f32 v192, v192, v193
  v_cvt_pk_bf16_f32 v194, v194, v195
  v_smfmac_f32_16x16x32_bf16 v[212:215], v[14:15], a[40:43], v22
  s_waitcnt lgkmcnt(0)
  v_cvt_pk_bf16_f32 v196, v196, v197
  v_cvt_pk_bf16_f32 v198, v198, v199
  v_smfmac_f32_16x16x32_bf16 v[216:219], v[12:13], a[44:47], v22
  v_accvgpr_write_b32 a32, v192
  v_accvgpr_write_b32 a33, v194
  v_smfmac_f32_16x16x32_bf16 v[220:223], v[14:15], a[44:47], v22
  buffer_load_dwordx4 v31, s[24:27], s53 offen offset:3264 lds
  v_mfma_f32_16x16x32_bf16 v[120:123], a[192:195], a[16:19], v[52:55]
  v_accvgpr_write_b32 a34, v196
  v_accvgpr_write_b32 a35, v198
  v_mfma_f32_16x16x32_bf16 v[120:123], a[196:199], a[20:23], v[120:123]
  v_cvt_pk_bf16_f32 v200, v200, v201
  v_cvt_pk_bf16_f32 v202, v202, v203
  v_mfma_f32_16x16x32_bf16 v[120:123], a[200:203], a[24:27], v[120:123]
  v_cvt_pk_bf16_f32 v204, v204, v205
  v_cvt_pk_bf16_f32 v206, v206, v207
  v_mfma_f32_16x16x32_bf16 v[120:123], a[204:207], a[28:31], v[120:123]
  v_accvgpr_write_b32 a36, v200
  v_accvgpr_write_b32 a37, v202
  v_mfma_f32_16x16x32_bf16 v[124:127], a[220:223], a[28:31], v[52:55]
  v_accvgpr_write_b32 a38, v204
  v_accvgpr_write_b32 a39, v206
  v_mfma_f32_16x16x32_bf16 v[124:127], a[216:219], a[24:27], v[124:127]
  v_cvt_pk_bf16_f32 v208, v208, v209
  v_cvt_pk_bf16_f32 v210, v210, v211
  v_mfma_f32_16x16x32_bf16 v[124:127], a[212:215], a[20:23], v[124:127]
  v_cvt_pk_bf16_f32 v212, v212, v213
  v_cvt_pk_bf16_f32 v214, v214, v215
  v_mfma_f32_16x16x32_bf16 v[124:127], a[208:211], a[16:19], v[124:127]
  v_accvgpr_write_b32 a40, v208
  v_accvgpr_write_b32 a41, v210
  v_mfma_f32_16x16x32_bf16 v[192:195], a[64:67], a[32:35], 0
  v_accvgpr_write_b32 a42, v212
  v_accvgpr_write_b32 a43, v214
  v_mfma_f32_16x16x32_bf16 v[196:199], a[80:83], a[32:35], 0
  v_cvt_pk_bf16_f32 v216, v216, v217
  v_cvt_pk_bf16_f32 v218, v218, v219
  v_mfma_f32_16x16x32_bf16 v[192:195], a[68:71], a[36:39], v[192:195]
  v_cvt_pk_bf16_f32 v220, v220, v221
  v_cvt_pk_bf16_f32 v222, v222, v223
  v_mfma_f32_16x16x32_bf16 v[196:199], a[84:87], a[36:39], v[196:199]
  v_accvgpr_write_b32 a44, v216
  v_accvgpr_write_b32 a45, v218
  v_mfma_f32_16x16x32_bf16 v[192:195], a[72:75], a[40:43], v[192:195]
  v_accvgpr_write_b32 a46, v220
  v_accvgpr_write_b32 a47, v222
  v_mfma_f32_16x16x32_bf16 v[196:199], a[88:91], a[40:43], v[196:199]
  s_waitcnt vmcnt(8)
  v_readlane_b32 s53, v32, 4
  v_mfma_f32_16x16x32_bf16 v[192:195], a[76:79], a[44:47], v[192:195]
  v_exp_f32 v118, v118
  v_mfma_f32_16x16x32_bf16 v[196:199], a[92:95], a[44:47], v[196:199]
  v_exp_f32 v119, v119
  s_add_u32 m0, s51, 43840
  v_cvt_pk_bf16_f32 v73, v114, v115
  buffer_load_dwordx4 v28, s[24:27], s53 offen offset:0 lds
  s_barrier
  ds_read_b64_tr_b16 a[130:131], v26 offset:18048
  ds_read_b64_tr_b16 a[128:129], v26 offset:17536
  ds_read_b64_tr_b16 a[162:163], v26 offset:26816
  ds_read_b64_tr_b16 a[160:161], v26 offset:26304
  ds_read_b64_tr_b16 a[166:167], v26 offset:26824
  ds_read_b64_tr_b16 a[164:165], v26 offset:26312
  ds_read_b64_tr_b16 a[134:135], v26 offset:18056
  buffer_load_dwordx4 v29, s[24:27], s53 offen offset:1088 lds
  ds_read_b64_tr_b16 a[132:133], v26 offset:17544
  ds_read_b64_tr_b16 a[138:139], v26 offset:18112
  ds_read_b64_tr_b16 a[136:137], v26 offset:17600
  ds_read_b64_tr_b16 a[170:171], v26 offset:26880
  ds_read_b64_tr_b16 a[168:169], v26 offset:26368
  ds_read_b64_tr_b16 a[174:175], v26 offset:26888
  ds_read_b64_tr_b16 a[172:173], v26 offset:26376
  v_max3_f32 v0, v192, v193, v194
  ds_read_b64_tr_b16 a[142:143], v26 offset:18120
  ds_read_b64_tr_b16 a[140:141], v26 offset:17608
  ds_read_b64_tr_b16 a[146:147], v26 offset:18176
  buffer_load_dwordx4 v30, s[24:27], s53 offen offset:2176 lds
  ds_read_b64_tr_b16 a[144:145], v26 offset:17664
  ds_read_b64_tr_b16 a[178:179], v26 offset:26944
  ds_read_b64_tr_b16 a[176:177], v26 offset:26432
  s_waitcnt lgkmcnt(15)
  v_mfma_f32_16x16x32_bf16 v[128:131], a[128:131], v[64:67], v[128:131]
  s_waitcnt lgkmcnt(15)
  v_max3_f32 v1, v195, v196, v197
  v_max3_f32 v0, v0, v198, v199
  v_mfma_f32_16x16x32_bf16 v[128:131], a[160:163], v[68:71], v[128:131]
  s_waitcnt lgkmcnt(14)
  ds_read_b64_tr_b16 a[182:183], v26 offset:26952
  ds_read_b64_tr_b16 a[180:181], v26 offset:26440
  v_mfma_f32_16x16x32_bf16 v[132:135], a[164:167], v[68:71], v[132:135]
  s_waitcnt lgkmcnt(14)
  v_max_f32 v0, v0, v1
  v_mov_b32 v1, v0
  v_mfma_f32_16x16x32_bf16 v[132:135], a[132:135], v[64:67], v[132:135]
  s_waitcnt lgkmcnt(12)
  buffer_load_dwordx4 v31, s[24:27], s53 offen offset:3264 lds
  v_mfma_f32_16x16x32_bf16 v[136:139], a[136:139], v[64:67], v[136:139]
  s_waitcnt lgkmcnt(10)
  ds_read_b64_tr_b16 a[150:151], v26 offset:18184
  ds_read_b64_tr_b16 a[148:149], v26 offset:17672
  v_mfma_f32_16x16x32_bf16 v[136:139], a[168:171], v[68:71], v[136:139]
  s_waitcnt lgkmcnt(10)
  v_permlane32_swap_b32 v0, v1
  v_mfma_f32_16x16x32_bf16 v[140:143], a[172:175], v[68:71], v[140:143]
  s_waitcnt lgkmcnt(8)
  ds_read_b64_tr_b16 a[154:155], v26 offset:18240
  ds_read_b64_tr_b16 a[152:153], v26 offset:17728
  v_mfma_f32_16x16x32_bf16 v[140:143], a[140:143], v[64:67], v[140:143]
  s_waitcnt lgkmcnt(8)
  v_max_f32 v0, v0, v1
  v_mov_b32 v1, v0
  v_mfma_f32_16x16x32_bf16 v[144:147], a[144:147], v[64:67], v[144:147]
  s_waitcnt lgkmcnt(6)
  ds_read_b64_tr_b16 a[186:187], v26 offset:27008
  ds_read_b64_tr_b16 a[184:185], v26 offset:26496
  v_mfma_f32_16x16x32_bf16 v[144:147], a[176:179], v[68:71], v[144:147]
  s_waitcnt lgkmcnt(6)
  v_permlane16_swap_b32 v0, v1
  v_mfma_f32_16x16x32_bf16 v[148:151], a[180:183], v[68:71], v[148:151]
  ds_read_b64_tr_b16 a[190:191], v26 offset:27016
  ds_read_b64_tr_b16 a[188:189], v26 offset:26504
  v_max_f32 v0, v0, v1
  v_cvt_pk_bf16_f32 v74, v116, v117
  v_cvt_pk_bf16_f32 v75, v118, v119
  s_waitcnt lgkmcnt(6)
  v_mfma_f32_16x16x32_bf16 v[148:151], a[148:151], v[64:67], v[148:151]
  ds_read_b64_tr_b16 a[158:159], v26 offset:18248
  ds_read_b64_tr_b16 a[156:157], v26 offset:17736
  v_exp_f32 v120, v120
  v_pk_add_f32 v[56:57], s[34:35], v[0:1] op_sel_hi:[1,0] neg_lo:[0,1] neg_hi:[0,1]
  s_waitcnt lgkmcnt(6)
  v_mfma_f32_16x16x32_bf16 v[152:155], a[152:155], v[64:67], v[152:155]
  v_exp_f32 v121, v121
  v_exp_f32 v122, v122
  v_pk_add_f32 v[58:59], s[34:35], v[0:1] op_sel_hi:[1,0] neg_lo:[0,1] neg_hi:[0,1]
  s_waitcnt lgkmcnt(4)
  v_mfma_f32_16x16x32_bf16 v[152:155], a[184:187], v[68:71], v[152:155]
  v_exp_f32 v123, v123
  v_exp_f32 v124, v124
  v_pk_add_f32 v[192:193], v[192:193], v[56:57]
  s_waitcnt lgkmcnt(2)
  v_mfma_f32_16x16x32_bf16 v[156:159], a[188:191], v[68:71], v[156:159]
  v_exp_f32 v192, v192
  v_exp_f32 v193, v193
  v_cvt_pk_bf16_f32 v76, v120, v121
  s_waitcnt lgkmcnt(0)
  v_mfma_f32_16x16x32_bf16 v[156:159], a[156:159], v[64:67], v[156:159]
  v_cvt_pk_bf16_f32 v40, v192, v193
  v_cvt_pk_bf16_f32 v77, v122, v123
  v_smfmac_f32_16x16x64_bf16 v[80:83], v[36:39], v[64:71], v35
  v_exp_f32 v125, v125
  v_exp_f32 v126, v126
  v_cvt_pk_bf16_f32 v78, v124, v125
  v_pk_add_f32 v[194:195], v[194:195], v[56:57]
  v_pk_add_f32 v[196:197], v[196:197], v[56:57]
  v_pk_add_f32 v[198:199], v[198:199], v[56:57]
  v_mfma_f32_16x16x32_bf16 v[96:99], a[96:99], a[32:35], v[56:59]
  v_exp_f32 v194, v194
  v_mfma_f32_16x16x32_bf16 v[96:99], a[100:103], a[36:39], v[96:99]
  v_exp_f32 v195, v195
  v_mfma_f32_16x16x32_bf16 v[96:99], a[104:107], a[40:43], v[96:99]
  v_exp_f32 v196, v196
  v_mfma_f32_16x16x32_bf16 v[96:99], a[108:111], a[44:47], v[96:99]
  v_exp_f32 v197, v197
  v_mfma_f32_16x16x32_bf16 v[100:103], a[124:127], a[44:47], v[56:59]
  v_exp_f32 v198, v198
  v_mfma_f32_16x16x32_bf16 v[100:103], a[120:123], a[40:43], v[100:103]
  v_exp_f32 v199, v199
  v_mfma_f32_16x16x32_bf16 v[100:103], a[116:119], a[36:39], v[100:103]
L_st0:
  s_cbranch_vccnz L_st4
  v_cvt_pk_bf16_f32 v41, v194, v195
  v_cvt_pk_bf16_f32 v42, v196, v197
  v_mfma_f32_16x16x32_bf16 v[100:103], a[112:115], a[32:35], v[100:103]
  v_cvt_pk_bf16_f32 v43, v198, v199
  v_exp_f32 v127, v127
  v_exp_f32 v96, v96
  v_mfma_f32_16x16x32_bf16 v[216:219], a[224:227], v[40:43], 0
  s_waitcnt vmcnt(8)
  ds_read_b128 a[48:51], v4 offset:49152
  ds_read_b128 a[52:55], v5 offset:49152
  v_mfma_f32_16x16x32_bf16 v[104:107], a[192:195], a[32:35], v[56:59]
  s_bfe_u32 s58, s2, 0x30003
  v_cvt_pk_bf16_f32 v79, v126, v127
  v_lshrrev_b32 v4, 2, v25
  v_mfma_f32_16x16x32_bf16 v[104:107], a[196:199], a[36:39], v[104:107]
  s_sub_u32 s58, s48, s58
  ds_read_b128 a[56:59], v6 offset:49152
  v_max3_f32 v216, abs(v216), abs(v217), abs(v218)
  v_mfma_f32_16x16x32_bf16 v[104:107], a[200:203], a[40:43], v[104:107]
  s_add_u32 m0, s51, 0
  ds_read_b128 a[60:63], v7 offset:49152
  v_max_f32_e64 v216, v216, abs(v219)
  v_mfma_f32_16x16x32_bf16 v[104:107], a[204:207], a[44:47], v[104:107]
  v_and_b32 v216, 0x7f800000, v216
  v_mul_f32 v220, 0x41800000, v216
  v_mfma_f32_16x16x32_bf16 v[108:111], a[220:223], a[44:47], v[56:59]
  v_mul_f32 v221, 0x41800000, v216
  v_mov_b64 v[222:223], v[220:221]
  v_mfma_f32_16x16x32_bf16 v[108:111], a[216:219], a[40:43], v[108:111]
  v_mul_f32 v18, 0xc1800000, v216
  v_lshl_add_u32 v4, v4, 13, s45
  v_mfma_f32_16x16x32_bf16 v[108:111], a[212:215], a[36:39], v[108:111]
  v_readlane_b32 s53, v32, 5
  v_mfma_f32_16x16x32_bf16 v[108:111], a[208:211], a[32:35], v[108:111]
  v_exp_f32 v97, v97
  v_mfma_f32_16x16x32_bf16 v[192:195], a[224:227], v[40:43], v[220:223]
  v_exp_f32 v98, v98
  v_mfma_f32_16x16x32_bf16 v[196:199], a[228:231], v[40:43], v[220:223]
  buffer_load_dwordx4 v28, s[24:27], s53 offen offset:0 lds
  v_mfma_f32_16x16x32_bf16 v[200:203], a[232:235], v[40:43], v[220:223]
  v_exp_f32 v99, v99
  v_mfma_f32_16x16x32_bf16 v[204:207], a[236:239], v[40:43], v[220:223]
  v_exp_f32 v100, v100
  v_mfma_f32_16x16x32_bf16 v[208:211], a[240:243], v[40:43], v[220:223]
  v_exp_f32 v101, v101
  v_mfma_f32_16x16x32_bf16 v[212:215], a[244:247], v[40:43], v[220:223]
  buffer_load_dwordx4 v29, s[24:27], s53 offen offset:1088 lds
  v_mfma_f32_16x16x32_bf16 v[216:219], a[248:251], v[40:43], v[220:223]
  v_exp_f32 v102, v102
  v_mfma_f32_16x16x32_bf16 v[220:223], a[252:255], v[40:43], v[220:223]
  s_waitcnt lgkmcnt(0)
  v_exp_f32 v103, v103
  v_smfmac_f32_16x16x32_bf16 v[224:227], v[12:13], a[48:51], v22
  v_cvt_pk_bf16_f32 v64, v96, v97
  v_cvt_pk_bf16_f32 v65, v98, v99
  v_smfmac_f32_16x16x32_bf16 v[228:231], v[14:15], a[48:51], v22
  buffer_load_dwordx4 v30, s[24:27], s53 offen offset:2176 lds
  v_smfmac_f32_16x16x32_bf16 v[232:235], v[12:13], a[52:55], v22
  v_cvt_pk_bf16_f32 v66, v100, v101
  v_cvt_pk_bf16_f32 v67, v102, v103
  v_smfmac_f32_16x16x32_bf16 v[236:239], v[14:15], a[52:55], v22
  v_cvt_pk_bf16_f32 v224, v224, v225
  v_cvt_pk_bf16_f32 v226, v226, v227
  v_smfmac_f32_16x16x32_bf16 v[240:243], v[12:13], a[56:59], v22
  v_cvt_pk_bf16_f32 v228, v228, v229
  v_cvt_pk_bf16_f32 v230, v230, v231
  v_smfmac_f32_16x16x32_bf16 v[244:247], v[14:15], a[56:59], v22
  v_accvgpr_write_b32 a48, v224
  v_accvgpr_write_b32 a49, v226
  v_smfmac_f32_16x16x32_bf16 v[248:251], v[12:13], a[60:63], v22
  v_accvgpr_write_b32 a50, v228
  v_accvgpr_write_b32 a51, v230
  v_smfmac_f32_16x16x32_bf16 v[252:255], v[14:15], a[60:63], v22
  v_cvt_pk_bf16_f32 v232, v232, v233
  v_cvt_pk_bf16_f32 v234, v234, v235
  v_mfma_f32_16x16x32_bf16 v[160:163], a[128:131], v[72:75], v[160:163]
  v_cvt_pk_bf16_f32 v236, v236, v237
  v_cvt_pk_bf16_f32 v238, v238, v239
  v_mfma_f32_16x16x32_bf16 v[160:163], a[160:163], v[76:79], v[160:163]
  v_accvgpr_write_b32 a52, v232
  v_accvgpr_write_b32 a53, v234
  v_mfma_f32_16x16x32_bf16 v[164:167], a[164:167], v[76:79], v[164:167]
  v_accvgpr_write_b32 a54, v236
  v_accvgpr_write_b32 a55, v238
  v_mfma_f32_16x16x32_bf16 v[164:167], a[132:135], v[72:75], v[164:167]
  v_cvt_pk_bf16_f32 v240, v240, v241
  v_cvt_pk_bf16_f32 v242, v242, v243
  v_mfma_f32_16x16x32_bf16 v[168:171], a[136:139], v[72:75], v[168:171]
  v_cvt_pk_bf16_f32 v244, v244, v245
  v_cvt_pk_bf16_f32 v246, v246, v247
  v_mfma_f32_16x16x32_bf16 v[168:171], a[168:171], v[76:79], v[168:171]
  v_accvgpr_write_b32 a56, v240
  v_accvgpr_write_b32 a57, v242
  v_mfma_f32_16x16x32_bf16 v[172:175], a[172:175], v[76:79], v[172:175]
  v_accvgpr_write_b32 a58, v244
  v_accvgpr_write_b32 a59, v246
  v_mfma_f32_16x16x32_bf16 v[172:175], a[140:143], v[72:75], v[172:175]
  v_cvt_pk_bf16_f32 v248, v248, v249
  v_cvt_pk_bf16_f32 v250, v250, v251
  v_mfma_f32_16x16x32_bf16 v[224:227], a[64:67], a[48:51], 0
  v_cvt_pk_bf16_f32 v252, v252, v253
  v_cvt_pk_bf16_f32 v254, v254, v255
  v_mfma_f32_16x16x32_bf16 v[228:231], a[80:83], a[48:51], 0
  v_accvgpr_write_b32 a60, v248
  v_accvgpr_write_b32 a61, v250
  v_mfma_f32_16x16x32_bf16 v[224:227], a[68:71], a[52:55], v[224:227]
  v_accvgpr_write_b32 a62, v252
  v_accvgpr_write_b32 a63, v254
  v_mfma_f32_16x16x32_bf16 v[228:231], a[84:87], a[52:55], v[228:231]
  buffer_load_dwordx4 v31, s[24:27], s53 offen offset:3264 lds
  v_mfma_f32_16x16x32_bf16 v[224:227], a[72:75], a[56:59], v[224:227]
  s_add_u32 m0, s51, 8768
  v_exp_f32 v104, v104
  v_mfma_f32_16x16x32_bf16 v[228:231], a[88:91], a[56:59], v[228:231]
  v_exp_f32 v105, v105
  v_mfma_f32_16x16x32_bf16 v[224:227], a[76:79], a[60:63], v[224:227]
  v_exp_f32 v106, v106
  v_mfma_f32_16x16x32_bf16 v[228:231], a[92:95], a[60:63], v[228:231]
  v_exp_f32 v107, v107
  v_mfma_f32_16x16x32_bf16 v[176:179], a[144:147], v[72:75], v[176:179]
  v_exp_f32 v108, v108
  v_mfma_f32_16x16x32_bf16 v[176:179], a[176:179], v[76:79], v[176:179]
  v_exp_f32 v109, v109
  v_mfma_f32_16x16x32_bf16 v[180:183], a[180:183], v[76:79], v[180:183]
  v_max3_f32 v2, v224, v225, v226
  v_cvt_pk_bf16_f32 v68, v104, v105
  v_mfma_f32_16x16x32_bf16 v[180:183], a[148:151], v[72:75], v[180:183]
  v_max3_f32 v3, v227, v228, v229
  v_max3_f32 v2, v2, v230, v231
  v_mfma_f32_16x16x32_bf16 v[184:187], a[152:155], v[72:75], v[184:187]
  v_max_f32 v2, v2, v3
  v_mov_b32 v3, v2
  v_mfma_f32_16x16x32_bf16 v[184:187], a[184:187], v[76:79], v[184:187]
  v_exp_f32 v110, v110
  v_mfma_f32_16x16x32_bf16 v[188:191], a[188:191], v[76:79], v[188:191]
  v_permlane32_swap_b32 v2, v3
  v_mfma_f32_16x16x32_bf16 v[188:191], a[156:159], v[72:75], v[188:191]
  v_max_f32 v2, v2, v3
  v_mov_b32 v3, v2
  v_smfmac_f32_16x16x64_bf16 v[84:87], v[36:39], v[72:79], v35
  v_exp_f32 v111, v111
  v_permlane16_swap_b32 v2, v3
  v_max_f32 v2, v2, v3
  v_pk_add_f32 v[60:61], s[34:35], v[2:3] op_sel_hi:[1,0] neg_lo:[0,1] neg_hi:[0,1]
  v_pk_add_f32 v[62:63], s[34:35], v[2:3] op_sel_hi:[1,0] neg_lo:[0,1] neg_hi:[0,1]
  v_pk_add_f32 v[224:225], v[224:225], v[60:61]
  v_pk_add_f32 v[226:227], v[226:227], v[60:61]
  v_pk_add_f32 v[228:229], v[228:229], v[60:61]
  v_pk_add_f32 v[230:231], v[230:231], v[60:61]
  v_mfma_f32_16x16x32_bf16 v[112:115], a[96:99], a[48:51], v[60:63]
  s_waitcnt vmcnt(4)
  v_exp_f32 v224, v224
  v_mfma_f32_16x16x32_bf16 v[112:115], a[100:103], a[52:55], v[112:115]
  v_exp_f32 v225, v225
  v_mfma_f32_16x16x32_bf16 v[112:115], a[104:107], a[56:59], v[112:115]
  v_exp_f32 v226, v226
  v_mfma_f32_16x16x32_bf16 v[112:115], a[108:111], a[60:63], v[112:115]
  v_exp_f32 v227, v227
  v_mfma_f32_16x16x32_bf16 v[116:119], a[124:127], a[60:63], v[60:63]
  v_exp_f32 v228, v228
  v_mfma_f32_16x16x32_bf16 v[116:119], a[120:123], a[56:59], v[116:119]
  v_exp_f32 v229, v229
  v_mfma_f32_16x16x32_bf16 v[116:119], a[116:119], a[52:55], v[116:119]
  v_exp_f32 v230, v230
  v_mfma_f32_16x16x32_bf16 v[116:119], a[112:115], a[48:51], v[116:119]
  v_exp_f32 v231, v231
  v_mfma_f32_16x16x32_bf16 v[120:123], a[192:195], a[48:51], v[60:63]
  s_barrier
  v_mfma_f32_16x16x32_bf16 v[120:123], a[196:199], a[52:55], v[120:123]
  ds_read_b128 a[64:67], v27 offset:35072
  v_cvt_pk_bf16_f32 v44, v224, v225
  v_mfma_f32_16x16x32_bf16 v[120:123], a[200:203], a[56:59], v[120:123]
  ds_read_b128 a[68:71], v27 offset:35136
  v_cvt_pk_bf16_f32 v45, v226, v227
  v_mfma_f32_16x16x32_bf16 v[120:123], a[204:207], a[60:63], v[120:123]
  ds_read_b128 a[72:75], v27 offset:35200
  v_cvt_pk_bf16_f32 v46, v228, v229
  v_mfma_f32_16x16x32_bf16 v[124:127], a[220:223], a[60:63], v[60:63]
  ds_read_b128 a[76:79], v27 offset:35264
  v_cvt_pk_bf16_f32 v47, v230, v231
  v_mfma_f32_16x16x32_bf16 v[124:127], a[216:219], a[56:59], v[124:127]
  ds_read_b128 a[92:95], v27 offset:35776
  v_cvt_pk_bf16_f32 v69, v106, v107
  v_mfma_f32_16x16x32_bf16 v[124:127], a[212:215], a[52:55], v[124:127]
  ds_read_b128 a[88:91], v27 offset:35712
  v_cvt_pk_bf16_f32 v70, v108, v109
  v_mfma_f32_16x16x32_bf16 v[124:127], a[208:211], a[48:51], v[124:127]
  ds_read_b128 a[84:87], v27 offset:35648
  v_cvt_pk_bf16_f32 v71, v110, v111
  v_mfma_f32_16x16x32_bf16 v[248:251], a[224:227], v[44:47], 0
  v_readlane_b32 s53, v32, 6
  v_smfmac_f32_16x16x64_bf16 v[90:93], v[36:39], v[40:47], v35
  ds_read_b128 a[80:83], v27 offset:35584
  v_and_b32 v5, 3, v25
  v_mfma_f32_16x16x32_bf16 v[192:195], a[128:131], v[64:67], v[192:195]
  ds_read_b128 a[96:99], v27 offset:43840
  v_lshl_add_u32 v4, v5, 6, v4
  v_mfma_f32_16x16x32_bf16 v[192:195], a[160:163], v[68:71], v[192:195]
  buffer_load_dwordx4 v28, s[24:27], s53 offen offset:0 lds
  v_mfma_f32_16x16x32_bf16 v[196:199], a[164:167], v[68:71], v[196:199]
  ds_read_b128 a[100:103], v27 offset:43904
  v_max3_f32 v248, abs(v248), abs(v249), abs(v250)
  v_mfma_f32_16x16x32_bf16 v[196:199], a[132:135], v[64:67], v[196:199]
  ds_read_b128 a[104:107], v27 offset:43968
  v_max_f32_e64 v248, v248, abs(v251)
  v_mfma_f32_16x16x32_bf16 v[200:203], a[136:139], v[64:67], v[200:203]
  ds_read_b128 a[108:111], v27 offset:44032
  v_and_b32 v248, 0x7f800000, v248
  v_mfma_f32_16x16x32_bf16 v[200:203], a[168:171], v[68:71], v[200:203]
  ds_read_b128 a[124:127], v27 offset:44544
  v_mul_f32 v252, 0x41800000, v248
  v_mfma_f32_16x16x32_bf16 v[204:207], a[172:175], v[68:71], v[204:207]
  ds_read_b128 a[120:123], v27 offset:44480
  v_mul_f32 v253, 0x41800000, v248
  v_mfma_f32_16x16x32_bf16 v[204:207], a[140:143], v[64:67], v[204:207]
  v_mov_b64 v[254:255], v[252:253]
  v_mul_f32 v19, 0xc1800000, v248
  v_exp_f32 v112, v112
  v_mfma_f32_16x16x32_bf16 v[224:227], a[224:227], v[44:47], v[252:255]
  buffer_load_dwordx4 v29, s[24:27], s53 offen offset:1088 lds
  v_mfma_f32_16x16x32_bf16 v[228:231], a[228:231], v[44:47], v[252:255]
  v_exp_f32 v113, v113
  v_mfma_f32_16x16x32_bf16 v[232:235], a[232:235], v[44:47], v[252:255]
  ds_read_b128 a[116:119], v27 offset:44416
  v_cvt_pk_bf16_f32 v72, v112, v113
  v_mfma_f32_16x16x32_bf16 v[236:239], a[236:239], v[44:47], v[252:255]
  v_exp_f32 v114, v114
  v_mfma_f32_16x16x32_bf16 v[240:243], a[240:243], v[44:47], v[252:255]
  buffer_load_dwordx4 v30, s[24:27], s53 offen offset:2176 lds
  v_mfma_f32_16x16x32_bf16 v[244:247], a[244:247], v[44:47], v[252:255]
  v_exp_f32 v115, v115
  v_mfma_f32_16x16x32_bf16 v[248:251], a[248:251], v[44:47], v[252:255]
  ds_read_b128 a[112:115], v27 offset:44352
  v_cvt_pk_bf16_f32 v73, v114, v115
  v_mfma_f32_16x16x32_bf16 v[252:255], a[252:255], v[44:47], v[252:255]
  v_exp_f32 v116, v116
  v_mfma_f32_16x16x32_bf16 v[208:211], a[144:147], v[64:67], v[208:211]
  buffer_load_dwordx4 v31, s[24:27], s53 offen offset:3264 lds
  v_mfma_f32_16x16x32_bf16 v[208:211], a[176:179], v[68:71], v[208:211]
  v_readlane_b32 s53, v32, s58
  v_mfma_f32_16x16x32_bf16 v[212:215], a[180:183], v[68:71], v[212:215]
  v_exp_f32 v117, v117
  v_mfma_f32_16x16x32_bf16 v[212:215], a[148:151], v[64:67], v[212:215]
  v_exp_f32 v118, v118
  v_mfma_f32_16x16x32_bf16 v[216:219], a[152:155], v[64:67], v[216:219]
  buffer_load_dword v7, v4, s[24:27], s53 offen
  v_mfma_f32_16x16x32_bf16 v[216:219], a[184:187], v[68:71], v[216:219]
  v_exp_f32 v119, v119
  v_mfma_f32_16x16x32_bf16 v[220:223], a[188:191], v[68:71], v[220:223]
  s_waitcnt lgkmcnt(0)
  v_cvt_pk_bf16_f32 v74, v116, v117
  v_cvt_pk_bf16_f32 v75, v118, v119
  v_mfma_f32_16x16x32_bf16 v[220:223], a[156:159], v[64:67], v[220:223]
  v_exp_f32 v120, v120
  v_smfmac_f32_16x16x64_bf16 v[88:91], v[36:39], v[64:71], v35
  v_exp_f32 v121, v121
  v_exp_f32 v122, v122
  v_cvt_pk_bf16_f32 v76, v120, v121
  s_lshr_b32 s58, s44, 1
  s_cmp_eq_u32 s58, 1
  s_cbranch_scc1 L_loop1
L_prealign:
.p2align 6
L_loop0:
  v_mfma_f32_16x16x32_bf16 v[96:99], a[64:67], a[0:3], v[48:51]
  s_add_u32 s58, s50, s100
  s_cmp_eq_u32 s58, s101
  s_cselect_b32 s58, 0, s58
  v_mfma_f32_16x16x32_bf16 v[96:99], a[68:71], a[4:7], v[96:99]
  s_add_u32 m0, s51, s58
  s_cmp_le_u32 s52, s48
  s_cselect_b32 s26, s38, 0
  v_mfma_f32_16x16x32_bf16 v[96:99], a[72:75], a[8:11], v[96:99]
  s_mov_b32 s33, s50
  v_exp_f32 v123, v123
  v_mfma_f32_16x16x32_bf16 v[96:99], a[76:79], a[12:15], v[96:99]
  v_exp_f32 v124, v124
  v_mfma_f32_16x16x32_bf16 v[100:103], a[92:95], a[12:15], v[48:51]
  v_exp_f32 v125, v125
  v_mfma_f32_16x16x32_bf16 v[100:103], a[88:91], a[8:11], v[100:103]
  v_exp_f32 v126, v126
  v_mfma_f32_16x16x32_bf16 v[100:103], a[84:87], a[4:7], v[100:103]
  v_exp_f32 v127, v127
  v_mfma_f32_16x16x32_bf16 v[100:103], a[80:83], a[0:3], v[100:103]
  v_cvt_pk_bf16_f32 v77, v122, v123
  v_cvt_pk_bf16_f32 v78, v124, v125
  v_mfma_f32_16x16x32_bf16 v[104:107], a[96:99], a[0:3], v[48:51]
  v_exp_f32 v96, v96
  v_mfma_f32_16x16x32_bf16 v[104:107], a[100:103], a[4:7], v[104:107]
  v_exp_f32 v97, v97
  v_mfma_f32_16x16x32_bf16 v[104:107], a[104:107], a[8:11], v[104:107]
  v_cvt_pk_bf16_f32 v79, v126, v127
  v_cvt_pk_bf16_f32 v64, v96, v97
  v_mfma_f32_16x16x32_bf16 v[104:107], a[108:111], a[12:15], v[104:107]
  v_exp_f32 v98, v98
  v_mfma_f32_16x16x32_bf16 v[108:111], a[124:127], a[12:15], v[48:51]
  v_exp_f32 v99, v99
  v_mfma_f32_16x16x32_bf16 v[108:111], a[120:123], a[8:11], v[108:111]
  v_exp_f32 v100, v100
  v_mfma_f32_16x16x32_bf16 v[108:111], a[116:119], a[4:7], v[108:111]
  v_exp_f32 v101, v101
  v_mfma_f32_16x16x32_bf16 v[108:111], a[112:115], a[0:3], v[108:111]
  v_exp_f32 v102, v102
  v_mfma_f32_16x16x32_bf16 v[224:227], a[128:131], v[72:75], v[224:227]
  v_exp_f32 v103, v103
  v_mfma_f32_16x16x32_bf16 v[224:227], a[160:163], v[76:79], v[224:227]
  ds_read_b64_tr_b16 a[130:131], v33 offset:512
  ds_read_b64_tr_b16 a[128:129], v33 offset:0
  v_mfma_f32_16x16x32_bf16 v[228:231], a[164:167], v[76:79], v[228:231]
  v_cvt_pk_bf16_f32 v65, v98, v99
  v_cvt_pk_bf16_f32 v66, v100, v101
  v_mfma_f32_16x16x32_bf16 v[228:231], a[132:135], v[72:75], v[228:231]
  ds_read_b64_tr_b16 a[162:163], v33 offset:9280
  ds_read_b64_tr_b16 a[160:161], v33 offset:8768
  v_mfma_f32_16x16x32_bf16 v[232:235], a[136:139], v[72:75], v[232:235]
  v_exp_f32 v104, v104
  v_mfma_f32_16x16x32_bf16 v[232:235], a[168:171], v[76:79], v[232:235]
  ds_read_b64_tr_b16 a[166:167], v33 offset:9288
  ds_read_b64_tr_b16 a[164:165], v33 offset:8776
  v_mfma_f32_16x16x32_bf16 v[236:239], a[172:175], v[76:79], v[236:239]
  v_exp_f32 v105, v105
  v_mfma_f32_16x16x32_bf16 v[236:239], a[140:143], v[72:75], v[236:239]
  ds_read_b64_tr_b16 a[134:135], v33 offset:520
  ds_read_b64_tr_b16 a[132:133], v33 offset:8
  v_mfma_f32_16x16x32_bf16 v[240:243], a[144:147], v[72:75], v[240:243]
  v_cvt_pk_bf16_f32 v67, v102, v103
  v_cvt_pk_bf16_f32 v68, v104, v105
  v_mfma_f32_16x16x32_bf16 v[240:243], a[176:179], v[76:79], v[240:243]
  ds_read_b64_tr_b16 a[138:139], v33 offset:576
  ds_read_b64_tr_b16 a[136:137], v33 offset:64
  v_mfma_f32_16x16x32_bf16 v[244:247], a[180:183], v[76:79], v[244:247]
  v_exp_f32 v106, v106
  v_mfma_f32_16x16x32_bf16 v[244:247], a[148:151], v[72:75], v[244:247]
  ds_read_b64_tr_b16 a[170:171], v33 offset:9344
  ds_read_b64_tr_b16 a[168:169], v33 offset:8832
  v_mfma_f32_16x16x32_bf16 v[248:251], a[152:155], v[72:75], v[248:251]
  v_exp_f32 v107, v107
  v_mfma_f32_16x16x32_bf16 v[248:251], a[184:187], v[76:79], v[248:251]
  ds_read_b64_tr_b16 a[174:175], v33 offset:9352
  ds_read_b64_tr_b16 a[172:173], v33 offset:8840
  v_mfma_f32_16x16x32_bf16 v[252:255], a[188:191], v[76:79], v[252:255]
  v_exp_f32 v108, v108
  v_mfma_f32_16x16x32_bf16 v[252:255], a[156:159], v[72:75], v[252:255]
  ds_read_b64_tr_b16 a[142:143], v33 offset:584
  ds_read_b64_tr_b16 a[140:141], v33 offset:72
  v_smfmac_f32_16x16x64_bf16 v[92:95], v[36:39], v[72:79], v35
  v_exp_f32 v109, v109
  v_mfma_f32_16x16x32_bf16 v[112:115], a[64:67], a[16:19], v[52:55]
  ds_read_b64_tr_b16 a[146:147], v33 offset:640
  ds_read_b64_tr_b16 a[144:145], v33 offset:128
  v_mfma_f32_16x16x32_bf16 v[112:115], a[68:71], a[20:23], v[112:115]
  v_exp_f32 v110, v110
  v_mfma_f32_16x16x32_bf16 v[112:115], a[72:75], a[24:27], v[112:115]
  ds_read_b64_tr_b16 a[178:179], v33 offset:9408
  ds_read_b64_tr_b16 a[176:177], v33 offset:8896
  v_mfma_f32_16x16x32_bf16 v[112:115], a[76:79], a[28:31], v[112:115]
  v_exp_f32 v111, v111
  v_mfma_f32_16x16x32_bf16 v[116:119], a[92:95], a[28:31], v[52:55]
  ds_read_b64_tr_b16 a[182:183], v33 offset:9416
  ds_read_b64_tr_b16 a[180:181], v33 offset:8904
  v_mfma_f32_16x16x32_bf16 v[116:119], a[88:91], a[24:27], v[116:119]
  v_cvt_pk_bf16_f32 v69, v106, v107
  v_cvt_pk_bf16_f32 v70, v108, v109
  v_mfma_f32_16x16x32_bf16 v[116:119], a[84:87], a[20:23], v[116:119]
  ds_read_b64_tr_b16 a[150:151], v33 offset:648
  v_cvt_pk_bf16_f32 v71, v110, v111
  v_mfma_f32_16x16x32_bf16 v[116:119], a[80:83], a[16:19], v[116:119]
  v_exp_f32 v112, v112
  v_mfma_f32_16x16x32_bf16 v[120:123], a[96:99], a[16:19], v[52:55]
  ds_read_b64_tr_b16 a[148:149], v33 offset:136
  ds_read_b64_tr_b16 a[154:155], v33 offset:704
  v_mfma_f32_16x16x32_bf16 v[120:123], a[100:103], a[20:23], v[120:123]
  v_exp_f32 v113, v113
  v_mfma_f32_16x16x32_bf16 v[120:123], a[104:107], a[24:27], v[120:123]
  ds_read_b64_tr_b16 a[152:153], v33 offset:192
  ds_read_b64_tr_b16 a[186:187], v33 offset:9472
  v_mfma_f32_16x16x32_bf16 v[120:123], a[108:111], a[28:31], v[120:123]
  v_exp_f32 v114, v114
  v_mfma_f32_16x16x32_bf16 v[124:127], a[124:127], a[28:31], v[52:55]
  ds_read_b64_tr_b16 a[184:185], v33 offset:8960
  ds_read_b64_tr_b16 a[190:191], v33 offset:9480
  v_mfma_f32_16x16x32_bf16 v[124:127], a[120:123], a[24:27], v[124:127]
  v_exp_f32 v115, v115
  v_mfma_f32_16x16x32_bf16 v[124:127], a[116:119], a[20:23], v[124:127]
  ds_read_b64_tr_b16 a[188:189], v33 offset:8968
  ds_read_b64_tr_b16 a[158:159], v33 offset:712
  v_mfma_f32_16x16x32_bf16 v[124:127], a[112:115], a[16:19], v[124:127]
  s_waitcnt lgkmcnt(8)
  v_exp_f32 v116, v116
  v_mfma_f32_16x16x32_bf16 v[128:131], a[128:131], v[64:67], v[128:131]
  ds_read_b64_tr_b16 a[156:157], v33 offset:200
  v_cvt_pk_bf16_f32 v72, v112, v113
  v_mfma_f32_16x16x32_bf16 v[128:131], a[160:163], v[68:71], v[128:131]
  v_exp_f32 v117, v117
  v_mfma_f32_16x16x32_bf16 v[132:135], a[164:167], v[68:71], v[132:135]
  v_exp_f32 v118, v118
  v_mfma_f32_16x16x32_bf16 v[132:135], a[132:135], v[64:67], v[132:135]
  v_exp_f32 v119, v119
  v_mfma_f32_16x16x32_bf16 v[136:139], a[136:139], v[64:67], v[136:139]
  v_readlane_b32 s53, v32, s52
  v_mfma_f32_16x16x32_bf16 v[136:139], a[168:171], v[68:71], v[136:139]
  v_cvt_pk_bf16_f32 v73, v114, v115
  v_cvt_pk_bf16_f32 v74, v116, v117
  v_mfma_f32_16x16x32_bf16 v[140:143], a[172:175], v[68:71], v[140:143]
  v_cvt_pk_bf16_f32 v75, v118, v119
  v_add_u32 v33, s50, v26
  v_mfma_f32_16x16x32_bf16 v[140:143], a[140:143], v[64:67], v[140:143]
  s_add_u32 s52, s52, 1
  s_cmp_le_u32 s52, s48
  s_mov_b32 s50, s58
  v_mfma_f32_16x16x32_bf16 v[144:147], a[144:147], v[64:67], v[144:147]
  buffer_load_dwordx4 v28, s[24:27], s53 offen offset:0 lds
  v_mfma_f32_16x16x32_bf16 v[144:147], a[176:179], v[68:71], v[144:147]
  v_exp_f32 v120, v120
  v_mfma_f32_16x16x32_bf16 v[148:151], a[180:183], v[68:71], v[148:151]
  s_waitcnt lgkmcnt(0)
  v_exp_f32 v121, v121
  v_mfma_f32_16x16x32_bf16 v[148:151], a[148:151], v[64:67], v[148:151]
  v_exp_f32 v122, v122
  v_mfma_f32_16x16x32_bf16 v[152:155], a[152:155], v[64:67], v[152:155]
  buffer_load_dwordx4 v29, s[24:27], s53 offen offset:1088 lds
  v_mfma_f32_16x16x32_bf16 v[152:155], a[184:187], v[68:71], v[152:155]
  v_exp_f32 v123, v123
  v_mfma_f32_16x16x32_bf16 v[156:159], a[188:191], v[68:71], v[156:159]
  v_exp_f32 v124, v124
  v_mfma_f32_16x16x32_bf16 v[156:159], a[156:159], v[64:67], v[156:159]
  v_exp_f32 v125, v125
  v_smfmac_f32_16x16x64_bf16 v[80:83], v[36:39], v[64:71], v35
  buffer_load_dwordx4 v30, s[24:27], s53 offen offset:2176 lds
  v_mfma_f32_16x16x32_bf16 v[96:99], a[64:67], a[32:35], v[56:59]
  v_exp_f32 v126, v126
  v_mfma_f32_16x16x32_bf16 v[96:99], a[68:71], a[36:39], v[96:99]
  v_exp_f32 v127, v127
  v_mfma_f32_16x16x32_bf16 v[96:99], a[72:75], a[40:43], v[96:99]
  v_cvt_pk_bf16_f32 v76, v120, v121
  v_cvt_pk_bf16_f32 v77, v122, v123
  v_mfma_f32_16x16x32_bf16 v[96:99], a[76:79], a[44:47], v[96:99]
  buffer_load_dwordx4 v31, s[24:27], s53 offen offset:3264 lds
  v_mfma_f32_16x16x32_bf16 v[100:103], a[92:95], a[44:47], v[56:59]
  s_cselect_b32 s26, s38, 0
  v_readlane_b32 s53, v32, s52
  v_mfma_f32_16x16x32_bf16 v[100:103], a[88:91], a[40:43], v[100:103]
  v_cvt_pk_bf16_f32 v78, v124, v125
  v_cvt_pk_bf16_f32 v79, v126, v127
  v_mfma_f32_16x16x32_bf16 v[100:103], a[84:87], a[36:39], v[100:103]
  v_exp_f32 v96, v96
  v_mfma_f32_16x16x32_bf16 v[100:103], a[80:83], a[32:35], v[100:103]
  s_add_u32 s52, s52, 1
  s_addk_i32 m0, 8768
  s_sub_u32 s49, s49, 1
  v_mfma_f32_16x16x32_bf16 v[104:107], a[96:99], a[32:35], v[56:59]
  buffer_load_dwordx4 v28, s[24:27], s53 offen offset:0 lds
  v_mfma_f32_16x16x32_bf16 v[104:107], a[100:103], a[36:39], v[104:107]
  s_cmp_lg_u32 s49, 0
  v_exp_f32 v97, v97
  v_mfma_f32_16x16x32_bf16 v[104:107], a[104:107], a[40:43], v[104:107]
  v_exp_f32 v98, v98
  v_mfma_f32_16x16x32_bf16 v[104:107], a[108:111], a[44:47], v[104:107]
  v_exp_f32 v99, v99
  v_mfma_f32_16x16x32_bf16 v[108:111], a[124:127], a[44:47], v[56:59]
  buffer_load_dwordx4 v29, s[24:27], s53 offen offset:1088 lds
  v_mfma_f32_16x16x32_bf16 v[108:111], a[120:123], a[40:43], v[108:111]
  v_exp_f32 v100, v100
  v_mfma_f32_16x16x32_bf16 v[108:111], a[116:119], a[36:39], v[108:111]
  v_exp_f32 v101, v101
  v_mfma_f32_16x16x32_bf16 v[108:111], a[112:115], a[32:35], v[108:111]
  v_exp_f32 v102, v102
  v_mfma_f32_16x16x32_bf16 v[160:163], a[128:131], v[72:75], v[160:163]
  buffer_load_dwordx4 v30, s[24:27], s53 offen offset:2176 lds
  v_mfma_f32_16x16x32_bf16 v[160:163], a[160:163], v[76:79], v[160:163]
  v_exp_f32 v103, v103
  v_mfma_f32_16x16x32_bf16 v[164:167], a[164:167], v[76:79], v[164:167]
  v_cvt_pk_bf16_f32 v64, v96, v97
  v_cvt_pk_bf16_f32 v65, v98, v99
  v_mfma_f32_16x16x32_bf16 v[164:167], a[132:135], v[72:75], v[164:167]
  v_cvt_pk_bf16_f32 v66, v100, v101
  v_cvt_pk_bf16_f32 v67, v102, v103
  v_mfma_f32_16x16x32_bf16 v[168:171], a[136:139], v[72:75], v[168:171]
  buffer_load_dwordx4 v31, s[24:27], s53 offen offset:3264 lds
  v_mfma_f32_16x16x32_bf16 v[168:171], a[168:171], v[76:79], v[168:171]
  v_exp_f32 v104, v104
  v_mfma_f32_16x16x32_bf16 v[172:175], a[172:175], v[76:79], v[172:175]
  v_exp_f32 v105, v105
  v_mfma_f32_16x16x32_bf16 v[172:175], a[140:143], v[72:75], v[172:175]
  v_exp_f32 v106, v106
  v_mfma_f32_16x16x32_bf16 v[176:179], a[144:147], v[72:75], v[176:179]
  v_exp_f32 v107, v107
  v_mfma_f32_16x16x32_bf16 v[176:179], a[176:179], v[76:79], v[176:179]
  v_exp_f32 v108, v108
  v_mfma_f32_16x16x32_bf16 v[180:183], a[180:183], v[76:79], v[180:183]
  v_exp_f32 v109, v109
  v_mfma_f32_16x16x32_bf16 v[180:183], a[148:151], v[72:75], v[180:183]
  v_exp_f32 v110, v110
  v_mfma_f32_16x16x32_bf16 v[184:187], a[152:155], v[72:75], v[184:187]
  v_exp_f32 v111, v111
  v_mfma_f32_16x16x32_bf16 v[184:187], a[184:187], v[76:79], v[184:187]
  v_cvt_pk_bf16_f32 v68, v104, v105
  v_cvt_pk_bf16_f32 v69, v106, v107
  v_mfma_f32_16x16x32_bf16 v[188:191], a[188:191], v[76:79], v[188:191]
  v_mfma_f32_16x16x32_bf16 v[188:191], a[156:159], v[72:75], v[188:191]
  s_waitcnt vmcnt(8)
  v_smfmac_f32_16x16x64_bf16 v[84:87], v[36:39], v[72:79], v35
  s_barrier
  v_mfma_f32_16x16x32_bf16 v[112:115], a[64:67], a[48:51], v[60:63]
  v_cvt_pk_bf16_f32 v70, v108, v109
  v_cvt_pk_bf16_f32 v71, v110, v111
  v_mfma_f32_16x16x32_bf16 v[112:115], a[68:71], a[52:55], v[112:115]
  v_mfma_f32_16x16x32_bf16 v[112:115], a[72:75], a[56:59], v[112:115]
  ds_read_b128 a[68:71], v34 offset:64
  ds_read_b128 a[64:67], v34 offset:0
  v_mfma_f32_16x16x32_bf16 v[112:115], a[76:79], a[60:63], v[112:115]
  v_mfma_f32_16x16x32_bf16 v[116:119], a[92:95], a[60:63], v[60:63]
  ds_read_b128 a[76:79], v34 offset:192
  ds_read_b128 a[72:75], v34 offset:128
  v_mfma_f32_16x16x32_bf16 v[116:119], a[88:91], a[56:59], v[116:119]
  v_mfma_f32_16x16x32_bf16 v[116:119], a[84:87], a[52:55], v[116:119]
  ds_read_b128 a[88:91], v34 offset:640
  ds_read_b128 a[92:95], v34 offset:704
  v_mfma_f32_16x16x32_bf16 v[116:119], a[80:83], a[48:51], v[116:119]
  v_exp_f32 v112, v112
  v_mfma_f32_16x16x32_bf16 v[120:123], a[96:99], a[48:51], v[60:63]
  ds_read_b128 a[80:83], v34 offset:512
  ds_read_b128 a[84:87], v34 offset:576
  v_mfma_f32_16x16x32_bf16 v[120:123], a[100:103], a[52:55], v[120:123]
  v_exp_f32 v113, v113
  v_mfma_f32_16x16x32_bf16 v[120:123], a[104:107], a[56:59], v[120:123]
  ds_read_b128 a[100:103], v34 offset:8832
  ds_read_b128 a[96:99], v34 offset:8768
  v_mfma_f32_16x16x32_bf16 v[120:123], a[108:111], a[60:63], v[120:123]
  v_exp_f32 v114, v114
  v_mfma_f32_16x16x32_bf16 v[124:127], a[124:127], a[60:63], v[60:63]
  ds_read_b128 a[108:111], v34 offset:8960
  ds_read_b128 a[104:107], v34 offset:8896
  v_mfma_f32_16x16x32_bf16 v[124:127], a[120:123], a[56:59], v[124:127]
  v_exp_f32 v115, v115
  v_mfma_f32_16x16x32_bf16 v[124:127], a[116:119], a[52:55], v[124:127]
  ds_read_b128 a[120:123], v34 offset:9408
  ds_read_b128 a[124:127], v34 offset:9472
  v_mfma_f32_16x16x32_bf16 v[124:127], a[112:115], a[48:51], v[124:127]
  v_exp_f32 v116, v116
  v_mfma_f32_16x16x32_bf16 v[192:195], a[128:131], v[64:67], v[192:195]
  ds_read_b128 a[112:115], v34 offset:9280
  ds_read_b128 a[116:119], v34 offset:9344
  v_mfma_f32_16x16x32_bf16 v[192:195], a[160:163], v[68:71], v[192:195]
  v_exp_f32 v117, v117
  v_mfma_f32_16x16x32_bf16 v[196:199], a[164:167], v[68:71], v[196:199]
  v_exp_f32 v118, v118
  v_mfma_f32_16x16x32_bf16 v[196:199], a[132:135], v[64:67], v[196:199]
  v_exp_f32 v119, v119
  v_mfma_f32_16x16x32_bf16 v[200:203], a[136:139], v[64:67], v[200:203]
  v_exp_f32 v120, v120
  v_mfma_f32_16x16x32_bf16 v[200:203], a[168:171], v[68:71], v[200:203]
  v_exp_f32 v121, v121
  v_mfma_f32_16x16x32_bf16 v[204:207], a[172:175], v[68:71], v[204:207]
  v_add_u32 v34, s58, v27
  v_cvt_pk_bf16_f32 v72, v112, v113
  v_mfma_f32_16x16x32_bf16 v[204:207], a[140:143], v[64:67], v[204:207]
  v_cvt_pk_bf16_f32 v73, v114, v115
  v_cvt_pk_bf16_f32 v74, v116, v117
  v_mfma_f32_16x16x32_bf16 v[208:211], a[144:147], v[64:67], v[208:211]
  v_cvt_pk_bf16_f32 v75, v118, v119
  v_cvt_pk_bf16_f32 v76, v120, v121
  v_mfma_f32_16x16x32_bf16 v[208:211], a[176:179], v[68:71], v[208:211]
  v_exp_f32 v122, v122
  v_mfma_f32_16x16x32_bf16 v[212:215], a[180:183], v[68:71], v[212:215]
  v_mfma_f32_16x16x32_bf16 v[212:215], a[148:151], v[64:67], v[212:215]
  v_mfma_f32_16x16x32_bf16 v[216:219], a[152:155], v[64:67], v[216:219]
  v_mfma_f32_16x16x32_bf16 v[216:219], a[184:187], v[68:71], v[216:219]
  v_mfma_f32_16x16x32_bf16 v[220:223], a[188:191], v[68:71], v[220:223]
  v_mfma_f32_16x16x32_bf16 v[220:223], a[156:159], v[64:67], v[220:223]
  s_waitcnt lgkmcnt(0)
  v_smfmac_f32_16x16x64_bf16 v[88:91], v[36:39], v[64:71], v35
  s_cbranch_scc1 L_loop0
  s_branch L_lexit
.p2align 6
L_st1:
  s_branch L_st5
.p2align 6
L_loop1:
  v_mfma_f32_16x16x32_bf16 v[96:99], a[64:67], a[0:3], v[48:51]
  s_add_u32 s58, s50, s100
  s_cmp_eq_u32 s58, s101
  s_cselect_b32 s58, 0, s58
  v_mfma_f32_16x16x32_bf16 v[96:99], a[68:71], a[4:7], v[96:99]
  s_add_u32 m0, s51, s58
  s_cmp_le_u32 s52, s48
  s_cselect_b32 s26, s38, 0
  v_mfma_f32_16x16x32_bf16 v[96:99], a[72:75], a[8:11], v[96:99]
  s_mov_b32 s33, s50
  v_exp_f32 v123, v123
  v_mfma_f32_16x16x32_bf16 v[96:99], a[76:79], a[12:15], v[96:99]
  v_exp_f32 v124, v124
  v_mfma_f32_16x16x32_bf16 v[100:103], a[92:95], a[12:15], v[48:51]
  v_exp_f32 v125, v125
  v_mfma_f32_16x16x32_bf16 v[100:103], a[88:91], a[8:11], v[100:103]
  v_exp_f32 v126, v126
  v_mfma_f32_16x16x32_bf16 v[100:103], a[84:87], a[4:7], v[100:103]
  v_exp_f32 v127, v127
  v_mfma_f32_16x16x32_bf16 v[100:103], a[80:83], a[0:3], v[100:103]
  v_cvt_pk_bf16_f32 v77, v122, v123
  v_cvt_pk_bf16_f32 v78, v124, v125
  v_mfma_f32_16x16x32_bf16 v[104:107], a[96:99], a[0:3], v[48:51]
  v_exp_f32 v96, v96
  v_mfma_f32_16x16x32_bf16 v[104:107], a[100:103], a[4:7], v[104:107]
  v_exp_f32 v97, v97
  v_mfma_f32_16x16x32_bf16 v[104:107], a[104:107], a[8:11], v[104:107]
  v_cvt_pk_bf16_f32 v79, v126, v127
  v_cvt_pk_bf16_f32 v64, v96, v97
  v_mfma_f32_16x16x32_bf16 v[104:107], a[108:111], a[12:15], v[104:107]
  v_exp_f32 v98, v98
  v_mfma_f32_16x16x32_bf16 v[108:111], a[124:127], a[12:15], v[48:51]
  v_exp_f32 v99, v99
  v_mfma_f32_16x16x32_bf16 v[108:111], a[120:123], a[8:11], v[108:111]
  v_exp_f32 v100, v100
  v_mfma_f32_16x16x32_bf16 v[108:111], a[116:119], a[4:7], v[108:111]
  v_exp_f32 v101, v101
  v_mfma_f32_16x16x32_bf16 v[108:111], a[112:115], a[0:3], v[108:111]
  v_exp_f32 v102, v102
  v_mfma_f32_16x16x32_bf16 v[224:227], a[128:131], v[72:75], v[224:227]
  v_exp_f32 v103, v103
  v_mfma_f32_16x16x32_bf16 v[224:227], a[160:163], v[76:79], v[224:227]
  v_cvt_pk_bf16_f32 v65, v98, v99
  v_cvt_pk_bf16_f32 v66, v100, v101
  v_mfma_f32_16x16x32_bf16 v[228:231], a[164:167], v[76:79], v[228:231]
  ds_read_b64_tr_b16 a[130:131], v33 offset:512
  ds_read_b64_tr_b16 a[128:129], v33 offset:0
  v_mfma_f32_16x16x32_bf16 v[228:231], a[132:135], v[72:75], v[228:231]
  v_exp_f32 v104, v104
  v_mfma_f32_16x16x32_bf16 v[232:235], a[136:139], v[72:75], v[232:235]
  ds_read_b64_tr_b16 a[162:163], v33 offset:9280
  ds_read_b64_tr_b16 a[160:161], v33 offset:8768
  v_mfma_f32_16x16x32_bf16 v[232:235], a[168:171], v[76:79], v[232:235]
  v_exp_f32 v105, v105
  v_mfma_f32_16x16x32_bf16 v[236:239], a[172:175], v[76:79], v[236:239]
  ds_read_b64_tr_b16 a[166:167], v33 offset:9288
  ds_read_b64_tr_b16 a[164:165], v33 offset:8776
  v_mfma_f32_16x16x32_bf16 v[236:239], a[140:143], v[72:75], v[236:239]
  v_cvt_pk_bf16_f32 v67, v102, v103
  v_cvt_pk_bf16_f32 v68, v104, v105
  v_mfma_f32_16x16x32_bf16 v[240:243], a[144:147], v[72:75], v[240:243]
  ds_read_b64_tr_b16 a[134:135], v33 offset:520
  ds_read_b64_tr_b16 a[132:133], v33 offset:8
  v_mfma_f32_16x16x32_bf16 v[240:243], a[176:179], v[76:79], v[240:243]
  v_exp_f32 v106, v106
  v_mfma_f32_16x16x32_bf16 v[244:247], a[180:183], v[76:79], v[244:247]
  ds_read_b64_tr_b16 a[138:139], v33 offset:576
  ds_read_b64_tr_b16 a[136:137], v33 offset:64
  v_mfma_f32_16x16x32_bf16 v[244:247], a[148:151], v[72:75], v[244:247]
  v_exp_f32 v107, v107
  v_mfma_f32_16x16x32_bf16 v[248:251], a[152:155], v[72:75], v[248:251]
  ds_read_b64_tr_b16 a[170:171], v33 offset:9344
  ds_read_b64_tr_b16 a[168:169], v33 offset:8832
  v_mfma_f32_16x16x32_bf16 v[248:251], a[184:187], v[76:79], v[248:251]
  v_exp_f32 v108, v108
  v_mfma_f32_16x16x32_bf16 v[252:255], a[188:191], v[76:79], v[252:255]
  ds_read_b64_tr_b16 a[174:175], v33 offset:9352
  ds_read_b64_tr_b16 a[172:173], v33 offset:8840
  v_mfma_f32_16x16x32_bf16 v[252:255], a[156:159], v[72:75], v[252:255]
  v_exp_f32 v109, v109
  v_smfmac_f32_16x16x64_bf16 v[92:95], v[36:39], v[72:79], v35
  ds_read_b64_tr_b16 a[142:143], v33 offset:584
  ds_read_b64_tr_b16 a[140:141], v33 offset:72
  v_mfma_f32_16x16x32_bf16 v[112:115], a[64:67], a[16:19], v[52:55]
  v_exp_f32 v110, v110
  v_mfma_f32_16x16x32_bf16 v[112:115], a[68:71], a[20:23], v[112:115]
  ds_read_b64_tr_b16 a[146:147], v33 offset:640
  ds_read_b64_tr_b16 a[144:145], v33 offset:128
  v_mfma_f32_16x16x32_bf16 v[112:115], a[72:75], a[24:27], v[112:115]
  v_exp_f32 v111, v111
  v_mfma_f32_16x16x32_bf16 v[112:115], a[76:79], a[28:31], v[112:115]
  ds_read_b64_tr_b16 a[178:179], v33 offset:9408
  ds_read_b64_tr_b16 a[176:177], v33 offset:8896
  v_mfma_f32_16x16x32_bf16 v[116:119], a[92:95], a[28:31], v[52:55]
  v_cvt_pk_bf16_f32 v69, v106, v107
  v_cvt_pk_bf16_f32 v70, v108, v109
  v_mfma_f32_16x16x32_bf16 v[116:119], a[88:91], a[24:27], v[116:119]
  ds_read_b64_tr_b16 a[182:183], v33 offset:9416
  ds_read_b64_tr_b16 a[180:181], v33 offset:8904
  v_mfma_f32_16x16x32_bf16 v[116:119], a[84:87], a[20:23], v[116:119]
  v_exp_f32 v112, v112
  v_mfma_f32_16x16x32_bf16 v[116:119], a[80:83], a[16:19], v[116:119]
  ds_read_b64_tr_b16 a[150:151], v33 offset:648
  v_cvt_pk_bf16_f32 v71, v110, v111
  v_mfma_f32_16x16x32_bf16 v[120:123], a[96:99], a[16:19], v[52:55]
  v_exp_f32 v113, v113
  v_mfma_f32_16x16x32_bf16 v[120:123], a[100:103], a[20:23], v[120:123]
  ds_read_b64_tr_b16 a[148:149], v33 offset:136
  ds_read_b64_tr_b16 a[154:155], v33 offset:704
  v_mfma_f32_16x16x32_bf16 v[120:123], a[104:107], a[24:27], v[120:123]
  v_exp_f32 v114, v114
  v_mfma_f32_16x16x32_bf16 v[120:123], a[108:111], a[28:31], v[120:123]
  ds_read_b64_tr_b16 a[152:153], v33 offset:192
  ds_read_b64_tr_b16 a[186:187], v33 offset:9472
  v_mfma_f32_16x16x32_bf16 v[124:127], a[124:127], a[28:31], v[52:55]
  v_exp_f32 v115, v115
  v_mfma_f32_16x16x32_bf16 v[124:127], a[120:123], a[24:27], v[124:127]
  ds_read_b64_tr_b16 a[184:185], v33 offset:8960
  ds_read_b64_tr_b16 a[190:191], v33 offset:9480
  v_mfma_f32_16x16x32_bf16 v[124:127], a[116:119], a[20:23], v[124:127]
  v_exp_f32 v116, v116
  v_mfma_f32_16x16x32_bf16 v[124:127], a[112:115], a[16:19], v[124:127]
  s_waitcnt lgkmcnt(6)
  ds_read_b64_tr_b16 a[188:189], v33 offset:8968
  ds_read_b64_tr_b16 a[158:159], v33 offset:712
  v_mfma_f32_16x16x32_bf16 v[128:131], a[128:131], v[64:67], v[128:131]
  v_exp_f32 v117, v117
  v_mfma_f32_16x16x32_bf16 v[128:131], a[160:163], v[68:71], v[128:131]
  ds_read_b64_tr_b16 a[156:157], v33 offset:200
  v_cvt_pk_bf16_f32 v72, v112, v113
  v_mfma_f32_16x16x32_bf16 v[132:135], a[164:167], v[68:71], v[132:135]
  v_exp_f32 v118, v118
  v_mfma_f32_16x16x32_bf16 v[132:135], a[132:135], v[64:67], v[132:135]
  v_exp_f32 v119, v119
  v_mfma_f32_16x16x32_bf16 v[136:139], a[136:139], v[64:67], v[136:139]
  v_cvt_pk_bf16_f32 v73, v114, v115
  v_cvt_pk_bf16_f32 v74, v116, v117
  v_mfma_f32_16x16x32_bf16 v[136:139], a[168:171], v[68:71], v[136:139]
  v_cvt_pk_bf16_f32 v75, v118, v119
  v_add_u32 v33, s50, v26
  v_mfma_f32_16x16x32_bf16 v[140:143], a[172:175], v[68:71], v[140:143]
  s_mov_b32 s50, s58
  v_readlane_b32 s53, v32, s52
  v_mfma_f32_16x16x32_bf16 v[140:143], a[140:143], v[64:67], v[140:143]
  v_exp_f32 v120, v120
  v_mfma_f32_16x16x32_bf16 v[144:147], a[144:147], v[64:67], v[144:147]
  s_waitcnt lgkmcnt(1)
  v_exp_f32 v121, v121
  v_mfma_f32_16x16x32_bf16 v[144:147], a[176:179], v[68:71], v[144:147]
  s_add_u32 s52, s52, 1
  s_cmp_le_u32 s52, s48
  v_cvt_pk_bf16_f32 v76, v120, v121
  v_mfma_f32_16x16x32_bf16 v[148:151], a[180:183], v[68:71], v[148:151]
  buffer_load_dwordx4 v28, s[24:27], s53 offen offset:0 lds
  v_mfma_f32_16x16x32_bf16 v[148:151], a[148:151], v[64:67], v[148:151]
  v_exp_f32 v122, v122
  v_mfma_f32_16x16x32_bf16 v[152:155], a[152:155], v[64:67], v[152:155]
  v_exp_f32 v123, v123
  v_mfma_f32_16x16x32_bf16 v[152:155], a[184:187], v[68:71], v[152:155]
  s_waitcnt lgkmcnt(0)
  v_exp_f32 v124, v124
  v_mfma_f32_16x16x32_bf16 v[156:159], a[188:191], v[68:71], v[156:159]
  buffer_load_dwordx4 v29, s[24:27], s53 offen offset:1088 lds
  v_mfma_f32_16x16x32_bf16 v[156:159], a[156:159], v[64:67], v[156:159]
  v_exp_f32 v125, v125
  v_smfmac_f32_16x16x64_bf16 v[80:83], v[36:39], v[64:71], v35
  v_exp_f32 v126, v126
  v_mfma_f32_16x16x32_bf16 v[96:99], a[64:67], a[32:35], v[56:59]
  v_exp_f32 v127, v127
  v_mfma_f32_16x16x32_bf16 v[96:99], a[68:71], a[36:39], v[96:99]
  buffer_load_dwordx4 v30, s[24:27], s53 offen offset:2176 lds
  v_mfma_f32_16x16x32_bf16 v[96:99], a[72:75], a[40:43], v[96:99]
  v_cvt_pk_bf16_f32 v77, v122, v123
  v_cvt_pk_bf16_f32 v78, v124, v125
  v_mfma_f32_16x16x32_bf16 v[96:99], a[76:79], a[44:47], v[96:99]
  v_cvt_pk_bf16_f32 v79, v126, v127
  v_mfma_f32_16x16x32_bf16 v[100:103], a[92:95], a[44:47], v[56:59]
  v_mfma_f32_16x16x32_bf16 v[100:103], a[88:91], a[40:43], v[100:103]
  buffer_load_dwordx4 v31, s[24:27], s53 offen offset:3264 lds
  v_mfma_f32_16x16x32_bf16 v[100:103], a[84:87], a[36:39], v[100:103]
  s_cselect_b32 s26, s38, 0
  v_readlane_b32 s53, v32, s52
  v_mfma_f32_16x16x32_bf16 v[100:103], a[80:83], a[32:35], v[100:103]
  v_exp_f32 v96, v96
  v_mfma_f32_16x16x32_bf16 v[104:107], a[96:99], a[32:35], v[56:59]
  v_exp_f32 v97, v97
  v_mfma_f32_16x16x32_bf16 v[104:107], a[100:103], a[36:39], v[104:107]
  s_add_u32 s52, s52, 1
  s_addk_i32 m0, 8768
  v_cvt_pk_bf16_f32 v64, v96, v97
  v_mfma_f32_16x16x32_bf16 v[104:107], a[104:107], a[40:43], v[104:107]
  buffer_load_dwordx4 v28, s[24:27], s53 offen offset:0 lds
  v_mfma_f32_16x16x32_bf16 v[104:107], a[108:111], a[44:47], v[104:107]
  s_sub_u32 s49, s49, 1
  v_exp_f32 v98, v98
  v_mfma_f32_16x16x32_bf16 v[108:111], a[124:127], a[44:47], v[56:59]
  s_cmp_lg_u32 s49, 0
  v_exp_f32 v99, v99
  v_mfma_f32_16x16x32_bf16 v[108:111], a[120:123], a[40:43], v[108:111]
  v_exp_f32 v100, v100
  v_mfma_f32_16x16x32_bf16 v[108:111], a[116:119], a[36:39], v[108:111]
  buffer_load_dwordx4 v29, s[24:27], s53 offen offset:1088 lds
  v_mfma_f32_16x16x32_bf16 v[108:111], a[112:115], a[32:35], v[108:111]
  v_exp_f32 v101, v101
  v_mfma_f32_16x16x32_bf16 v[160:163], a[128:131], v[72:75], v[160:163]
  v_exp_f32 v102, v102
  v_mfma_f32_16x16x32_bf16 v[160:163], a[160:163], v[76:79], v[160:163]
  v_exp_f32 v103, v103
  v_mfma_f32_16x16x32_bf16 v[164:167], a[164:167], v[76:79], v[164:167]
  buffer_load_dwordx4 v30, s[24:27], s53 offen offset:2176 lds
  v_mfma_f32_16x16x32_bf16 v[164:167], a[132:135], v[72:75], v[164:167]
  v_cvt_pk_bf16_f32 v65, v98, v99
  v_cvt_pk_bf16_f32 v66, v100, v101
  v_mfma_f32_16x16x32_bf16 v[168:171], a[136:139], v[72:75], v[168:171]
  v_exp_f32 v104, v104
  v_mfma_f32_16x16x32_bf16 v[168:171], a[168:171], v[76:79], v[168:171]
  v_exp_f32 v105, v105
  v_mfma_f32_16x16x32_bf16 v[172:175], a[172:175], v[76:79], v[172:175]
  buffer_load_dwordx4 v31, s[24:27], s53 offen offset:3264 lds
  v_mfma_f32_16x16x32_bf16 v[172:175], a[140:143], v[72:75], v[172:175]
  v_cvt_pk_bf16_f32 v67, v102, v103
  v_cvt_pk_bf16_f32 v68, v104, v105
  v_mfma_f32_16x16x32_bf16 v[176:179], a[144:147], v[72:75], v[176:179]
  v_exp_f32 v106, v106
  v_mfma_f32_16x16x32_bf16 v[176:179], a[176:179], v[76:79], v[176:179]
  v_exp_f32 v107, v107
  v_mfma_f32_16x16x32_bf16 v[180:183], a[180:183], v[76:79], v[180:183]
  v_exp_f32 v108, v108
  v_mfma_f32_16x16x32_bf16 v[180:183], a[148:151], v[72:75], v[180:183]
  v_exp_f32 v109, v109
  v_mfma_f32_16x16x32_bf16 v[184:187], a[152:155], v[72:75], v[184:187]
  v_exp_f32 v110, v110
  v_mfma_f32_16x16x32_bf16 v[184:187], a[184:187], v[76:79], v[184:187]
  v_exp_f32 v111, v111
  v_mfma_f32_16x16x32_bf16 v[188:191], a[188:191], v[76:79], v[188:191]
  v_mfma_f32_16x16x32_bf16 v[188:191], a[156:159], v[72:75], v[188:191]
  s_waitcnt vmcnt(8)
  v_smfmac_f32_16x16x64_bf16 v[84:87], v[36:39], v[72:79], v35
  s_barrier
  v_mfma_f32_16x16x32_bf16 v[112:115], a[64:67], a[48:51], v[60:63]
  v_cvt_pk_bf16_f32 v69, v106, v107
  v_cvt_pk_bf16_f32 v70, v108, v109
  v_mfma_f32_16x16x32_bf16 v[112:115], a[68:71], a[52:55], v[112:115]
  ds_read_b128 a[64:67], v34 offset:0
  v_cvt_pk_bf16_f32 v71, v110, v111
  v_mfma_f32_16x16x32_bf16 v[112:115], a[72:75], a[56:59], v[112:115]
  v_mfma_f32_16x16x32_bf16 v[112:115], a[76:79], a[60:63], v[112:115]
  ds_read_b128 a[72:75], v34 offset:128
  ds_read_b128 a[68:71], v34 offset:64
  v_mfma_f32_16x16x32_bf16 v[116:119], a[92:95], a[60:63], v[60:63]
  v_mfma_f32_16x16x32_bf16 v[116:119], a[88:91], a[56:59], v[116:119]
  ds_read_b128 a[92:95], v34 offset:704
  ds_read_b128 a[76:79], v34 offset:192
  v_mfma_f32_16x16x32_bf16 v[116:119], a[84:87], a[52:55], v[116:119]
  v_mfma_f32_16x16x32_bf16 v[116:119], a[80:83], a[48:51], v[116:119]
  ds_read_b128 a[84:87], v34 offset:576
  ds_read_b128 a[88:91], v34 offset:640
  v_mfma_f32_16x16x32_bf16 v[120:123], a[96:99], a[48:51], v[60:63]
  v_exp_f32 v112, v112
  v_mfma_f32_16x16x32_bf16 v[120:123], a[100:103], a[52:55], v[120:123]
  ds_read_b128 a[96:99], v34 offset:8768
  ds_read_b128 a[80:83], v34 offset:512
  v_mfma_f32_16x16x32_bf16 v[120:123], a[104:107], a[56:59], v[120:123]
  v_exp_f32 v113, v113
  v_mfma_f32_16x16x32_bf16 v[120:123], a[108:111], a[60:63], v[120:123]
  ds_read_b128 a[104:107], v34 offset:8896
  ds_read_b128 a[100:103], v34 offset:8832
  v_mfma_f32_16x16x32_bf16 v[124:127], a[124:127], a[60:63], v[60:63]
  v_exp_f32 v114, v114
  v_mfma_f32_16x16x32_bf16 v[124:127], a[120:123], a[56:59], v[124:127]
  ds_read_b128 a[124:127], v34 offset:9472
  ds_read_b128 a[108:111], v34 offset:8960
  v_mfma_f32_16x16x32_bf16 v[124:127], a[116:119], a[52:55], v[124:127]
  v_exp_f32 v115, v115
  v_mfma_f32_16x16x32_bf16 v[124:127], a[112:115], a[48:51], v[124:127]
  ds_read_b128 a[116:119], v34 offset:9344
  ds_read_b128 a[120:123], v34 offset:9408
  v_mfma_f32_16x16x32_bf16 v[192:195], a[128:131], v[64:67], v[192:195]
  v_exp_f32 v116, v116
  v_mfma_f32_16x16x32_bf16 v[192:195], a[160:163], v[68:71], v[192:195]
  ds_read_b128 a[112:115], v34 offset:9280
  v_add_u32 v34, s58, v27
  v_mfma_f32_16x16x32_bf16 v[196:199], a[164:167], v[68:71], v[196:199]
  v_exp_f32 v117, v117
  v_mfma_f32_16x16x32_bf16 v[196:199], a[132:135], v[64:67], v[196:199]
  v_exp_f32 v118, v118
  v_mfma_f32_16x16x32_bf16 v[200:203], a[136:139], v[64:67], v[200:203]
  v_exp_f32 v119, v119
  v_mfma_f32_16x16x32_bf16 v[200:203], a[168:171], v[68:71], v[200:203]
  v_exp_f32 v120, v120
  v_mfma_f32_16x16x32_bf16 v[204:207], a[172:175], v[68:71], v[204:207]
  v_exp_f32 v121, v121
  v_mfma_f32_16x16x32_bf16 v[204:207], a[140:143], v[64:67], v[204:207]
  v_cvt_pk_bf16_f32 v72, v112, v113
  v_cvt_pk_bf16_f32 v73, v114, v115
  v_mfma_f32_16x16x32_bf16 v[208:211], a[144:147], v[64:67], v[208:211]
  v_cvt_pk_bf16_f32 v74, v116, v117
  v_cvt_pk_bf16_f32 v75, v118, v119
  v_mfma_f32_16x16x32_bf16 v[208:211], a[176:179], v[68:71], v[208:211]
  v_exp_f32 v122, v122
  v_mfma_f32_16x16x32_bf16 v[212:215], a[180:183], v[68:71], v[212:215]
  v_cvt_pk_bf16_f32 v76, v120, v121
  v_mfma_f32_16x16x32_bf16 v[212:215], a[148:151], v[64:67], v[212:215]
  v_mfma_f32_16x16x32_bf16 v[216:219], a[152:155], v[64:67], v[216:219]
  v_mfma_f32_16x16x32_bf16 v[216:219], a[184:187], v[68:71], v[216:219]
  v_mfma_f32_16x16x32_bf16 v[220:223], a[188:191], v[68:71], v[220:223]
  v_mfma_f32_16x16x32_bf16 v[220:223], a[156:159], v[64:67], v[220:223]
  s_waitcnt lgkmcnt(0)
  v_smfmac_f32_16x16x64_bf16 v[88:91], v[36:39], v[64:71], v35
  s_cbranch_scc1 L_loop1
L_lexit:
  s_cmp_lg_u32 s46, 0
  s_cbranch_scc1 L_tail2
L_tail0:
  v_mfma_f32_16x16x32_bf16 v[96:99], a[64:67], a[0:3], v[48:51]
  ds_read_b64_tr_b16 a[194:195], v33 offset:512
  v_add_u32 v21, s50, v21
  v_mfma_f32_16x16x32_bf16 v[96:99], a[68:71], a[4:7], v[96:99]
  v_exp_f32 v123, v123
  v_mfma_f32_16x16x32_bf16 v[96:99], a[72:75], a[8:11], v[96:99]
  v_exp_f32 v124, v124
  v_mfma_f32_16x16x32_bf16 v[96:99], a[76:79], a[12:15], v[96:99]
  v_exp_f32 v125, v125
  v_mfma_f32_16x16x32_bf16 v[100:103], a[92:95], a[12:15], v[48:51]
  v_exp_f32 v126, v126
  v_mfma_f32_16x16x32_bf16 v[100:103], a[88:91], a[8:11], v[100:103]
  v_exp_f32 v127, v127
  v_mfma_f32_16x16x32_bf16 v[100:103], a[84:87], a[4:7], v[100:103]
  s_waitcnt vmcnt(0)
  ds_read_b64_tr_b16 a[192:193], v33 offset:0
  v_cvt_pk_bf16_f32 v77, v122, v123
  v_mfma_f32_16x16x32_bf16 v[100:103], a[80:83], a[0:3], v[100:103]
  s_barrier
  v_mfma_f32_16x16x32_bf16 v[104:107], a[96:99], a[0:3], v[48:51]
  ds_read_b128 a[224:227], v21 offset:8768
  ds_read_b128 a[228:231], v21 offset:8832
  v_mfma_f32_16x16x32_bf16 v[104:107], a[100:103], a[4:7], v[104:107]
  v_cvt_pk_bf16_f32 v78, v124, v125
  v_cvt_pk_bf16_f32 v79, v126, v127
  v_mfma_f32_16x16x32_bf16 v[104:107], a[104:107], a[8:11], v[104:107]
  ds_read_b128 a[232:235], v21 offset:8896
  v_add_f32 v120, v48, v8
  v_mfma_f32_16x16x32_bf16 v[104:107], a[108:111], a[12:15], v[104:107]
  v_add_f32 v121, v48, v9
  v_add_f32 v122, v48, v10
  v_mfma_f32_16x16x32_bf16 v[108:111], a[124:127], a[12:15], v[48:51]
  ds_read_b128 a[236:239], v21 offset:8960
  v_add_f32 v123, v48, v11
  v_mfma_f32_16x16x32_bf16 v[108:111], a[120:123], a[8:11], v[108:111]
  v_exp_f32 v96, v96
  v_mfma_f32_16x16x32_bf16 v[108:111], a[116:119], a[4:7], v[108:111]
  ds_read_b128 a[64:67], v34 offset:0
  v_add_u32 v13, s50, v26
  v_mfma_f32_16x16x32_bf16 v[108:111], a[112:115], a[0:3], v[108:111]
  ds_read_b128 a[68:71], v34 offset:64
  v_add_u32 v20, s50, v20
  v_mfma_f32_16x16x32_bf16 v[224:227], a[128:131], v[72:75], v[224:227]
  ds_read_b128 a[72:75], v34 offset:128
  v_mov_b64 v[46:47], 0
  v_mfma_f32_16x16x32_bf16 v[224:227], a[160:163], v[76:79], v[224:227]
  ds_read_b128 a[76:79], v34 offset:192
  v_add_u32 v12, s33, v27
  v_mfma_f32_16x16x32_bf16 v[228:231], a[164:167], v[76:79], v[228:231]
  v_exp_f32 v97, v97
  v_mfma_f32_16x16x32_bf16 v[228:231], a[132:135], v[72:75], v[228:231]
  ds_read_b128 a[92:95], v34 offset:704
  ds_read_b128 a[88:91], v34 offset:640
  v_mfma_f32_16x16x32_bf16 v[232:235], a[136:139], v[72:75], v[232:235]
  v_exp_f32 v98, v98
  v_mfma_f32_16x16x32_bf16 v[232:235], a[168:171], v[76:79], v[232:235]
  ds_read_b128 a[84:87], v34 offset:576
  ds_read_b128 a[80:83], v34 offset:512
  v_mfma_f32_16x16x32_bf16 v[236:239], a[172:175], v[76:79], v[236:239]
  v_exp_f32 v99, v99
  v_mfma_f32_16x16x32_bf16 v[236:239], a[140:143], v[72:75], v[236:239]
  ds_read_b64_tr_b16 a[130:131], v33 offset:9280
  ds_read_b64_tr_b16 a[128:129], v33 offset:8768
  v_mfma_f32_16x16x32_bf16 v[240:243], a[144:147], v[72:75], v[240:243]
  v_exp_f32 v100, v100
  v_mfma_f32_16x16x32_bf16 v[240:243], a[176:179], v[76:79], v[240:243]
  ds_read_b64_tr_b16 a[134:135], v33 offset:9288
  ds_read_b64_tr_b16 a[132:133], v33 offset:8776
  v_mfma_f32_16x16x32_bf16 v[244:247], a[180:183], v[76:79], v[244:247]
  v_exp_f32 v101, v101
  v_mfma_f32_16x16x32_bf16 v[244:247], a[148:151], v[72:75], v[244:247]
  ds_read_b64_tr_b16 a[198:199], v33 offset:520
  ds_read_b64_tr_b16 a[196:197], v33 offset:8
  v_mfma_f32_16x16x32_bf16 v[248:251], a[152:155], v[72:75], v[248:251]
  v_exp_f32 v102, v102
  v_mfma_f32_16x16x32_bf16 v[248:251], a[184:187], v[76:79], v[248:251]
  ds_read_b64_tr_b16 a[202:203], v33 offset:576
  ds_read_b64_tr_b16 a[200:201], v33 offset:64
  v_mfma_f32_16x16x32_bf16 v[252:255], a[188:191], v[76:79], v[252:255]
  v_exp_f32 v103, v103
  v_mfma_f32_16x16x32_bf16 v[252:255], a[156:159], v[72:75], v[252:255]
  ds_read_b64_tr_b16 a[138:139], v33 offset:9344
  ds_read_b64_tr_b16 a[136:137], v33 offset:8832
  v_smfmac_f32_16x16x64_bf16 v[92:95], v[36:39], v[72:79], v35
  s_waitcnt lgkmcnt(6)
  v_cvt_pk_bf16_f32 v64, v96, v97
  v_cvt_pk_bf16_f32 v65, v98, v99
  v_mfma_f32_16x16x32_bf16 v[120:123], a[224:227], a[0:3], v[120:123]
  ds_read_b64_tr_b16 a[142:143], v33 offset:9352
  ds_read_b64_tr_b16 a[140:141], v33 offset:8840
  v_mfma_f32_16x16x32_bf16 v[120:123], a[228:231], a[4:7], v[120:123]
  v_cvt_pk_bf16_f32 v66, v100, v101
  v_cvt_pk_bf16_f32 v67, v102, v103
  v_mfma_f32_16x16x32_bf16 v[120:123], a[232:235], a[8:11], v[120:123]
  ds_read_b64_tr_b16 a[206:207], v33 offset:584
  ds_read_b64_tr_b16 a[204:205], v33 offset:72
  v_mfma_f32_16x16x32_bf16 v[120:123], a[236:239], a[12:15], v[120:123]
  v_exp_f32 v104, v104
  v_mfma_f32_16x16x32_bf16 v[112:115], a[64:67], a[0:3], v[48:51]
  ds_read_b64_tr_b16 a[210:211], v33 offset:640
  ds_read_b64_tr_b16 a[208:209], v33 offset:128
  v_mfma_f32_16x16x32_bf16 v[112:115], a[68:71], a[4:7], v[112:115]
  v_exp_f32 v105, v105
  v_mfma_f32_16x16x32_bf16 v[112:115], a[72:75], a[8:11], v[112:115]
  ds_read_b64_tr_b16 a[146:147], v33 offset:9408
  ds_read_b64_tr_b16 a[144:145], v33 offset:8896
  v_mfma_f32_16x16x32_bf16 v[112:115], a[76:79], a[12:15], v[112:115]
  v_exp_f32 v106, v106
  v_mfma_f32_16x16x32_bf16 v[116:119], a[92:95], a[12:15], v[48:51]
  v_exp_f32 v107, v107
  v_mfma_f32_16x16x32_bf16 v[116:119], a[88:91], a[8:11], v[116:119]
  v_exp_f32 v108, v108
  v_mfma_f32_16x16x32_bf16 v[116:119], a[84:87], a[4:7], v[116:119]
  v_exp_f32 v109, v109
  v_mfma_f32_16x16x32_bf16 v[116:119], a[80:83], a[0:3], v[116:119]
  v_exp_f32 v110, v110
  v_mfma_f32_16x16x32_bf16 v[128:131], a[192:195], v[64:67], v[128:131]
  v_exp_f32 v111, v111
  ds_read_b64_tr_b16 a[150:151], v33 offset:9416
  v_cvt_pk_bf16_f32 v68, v104, v105
  v_cvt_pk_bf16_f32 v69, v106, v107
  v_cvt_pk_bf16_f32 v70, v108, v109
  v_cvt_pk_bf16_f32 v71, v110, v111
  ds_read_b64_tr_b16 a[148:149], v33 offset:8904
  ds_read_b64_tr_b16 a[214:215], v33 offset:648
  v_mfma_f32_16x16x32_bf16 v[128:131], a[128:131], v[68:71], v[128:131]
  v_exp_f32 v120, v120
  v_mfma_f32_16x16x32_bf16 v[132:135], a[132:135], v[68:71], v[132:135]
  s_waitcnt lgkmcnt(3)
  ds_read_b64_tr_b16 a[212:213], v33 offset:136
  ds_read_b64_tr_b16 a[218:219], v33 offset:704
  v_mfma_f32_16x16x32_bf16 v[132:135], a[196:199], v[64:67], v[132:135]
  v_exp_f32 v121, v121
  v_mfma_f32_16x16x32_bf16 v[136:139], a[200:203], v[64:67], v[136:139]
  ds_read_b64_tr_b16 a[216:217], v33 offset:192
  ds_read_b64_tr_b16 a[154:155], v33 offset:9472
  v_mfma_f32_16x16x32_bf16 v[136:139], a[136:139], v[68:71], v[136:139]
  v_exp_f32 v122, v122
  v_mfma_f32_16x16x32_bf16 v[140:143], a[140:143], v[68:71], v[140:143]
  ds_read_b64_tr_b16 a[152:153], v33 offset:8960
  ds_read_b64_tr_b16 a[158:159], v33 offset:9480
  v_mfma_f32_16x16x32_bf16 v[140:143], a[204:207], v[64:67], v[140:143]
  v_exp_f32 v123, v123
  v_mfma_f32_16x16x32_bf16 v[144:147], a[208:211], v[64:67], v[144:147]
  ds_read_b64_tr_b16 a[156:157], v33 offset:8968
  ds_read_b64_tr_b16 a[222:223], v33 offset:712
  v_mfma_f32_16x16x32_bf16 v[144:147], a[144:147], v[68:71], v[144:147]
  s_waitcnt lgkmcnt(6)
  v_exp_f32 v112, v112
  v_mfma_f32_16x16x32_bf16 v[148:151], a[148:151], v[68:71], v[148:151]
  ds_read_b64_tr_b16 a[220:221], v33 offset:200
  ds_read_b64_tr_b16 a[162:163], v13 offset:512
  v_mfma_f32_16x16x32_bf16 v[148:151], a[212:215], v[64:67], v[148:151]
  s_waitcnt lgkmcnt(6)
  v_exp_f32 v113, v113
  v_mfma_f32_16x16x32_bf16 v[152:155], a[216:219], v[64:67], v[152:155]
  s_waitcnt lgkmcnt(4)
  ds_read_b64_tr_b16 a[160:161], v13 offset:0
  ds_read_b64_tr_b16 a[166:167], v13 offset:520
  v_mfma_f32_16x16x32_bf16 v[152:155], a[152:155], v[68:71], v[152:155]
  s_waitcnt lgkmcnt(5)
  v_exp_f32 v114, v114
  v_mfma_f32_16x16x32_bf16 v[156:159], a[156:159], v[68:71], v[156:159]
  ds_read_b64_tr_b16 a[164:165], v13 offset:8
  ds_read_b64_tr_b16 a[240:241], v20 offset:8768
  v_exp_f32 v115, v115
  s_waitcnt lgkmcnt(5)
  v_mfma_f32_16x16x32_bf16 v[156:159], a[220:223], v[64:67], v[156:159]
  ds_read_b64_tr_b16 a[242:243], v20 offset:8776
  ds_read_b64_tr_b16 a[178:179], v13 offset:640
  v_smfmac_f32_16x16x64_bf16 v[80:83], v[36:39], v[64:71], v35
  v_exp_f32 v116, v116
  v_mfma_f32_16x16x32_bf16 v[96:99], a[64:67], a[16:19], v[52:55]
  ds_read_b64_tr_b16 a[176:177], v13 offset:128
  ds_read_b64_tr_b16 a[182:183], v13 offset:648
  v_mfma_f32_16x16x32_bf16 v[96:99], a[68:71], a[20:23], v[96:99]
  v_exp_f32 v117, v117
  v_mfma_f32_16x16x32_bf16 v[96:99], a[72:75], a[24:27], v[96:99]
  ds_read_b64_tr_b16 a[180:181], v13 offset:136
  ds_read_b64_tr_b16 a[248:249], v20 offset:8896
  v_mfma_f32_16x16x32_bf16 v[96:99], a[76:79], a[28:31], v[96:99]
L_st2:
  s_cbranch_vccnz L_st6
  v_exp_f32 v118, v118
  v_mfma_f32_16x16x32_bf16 v[100:103], a[92:95], a[28:31], v[52:55]
  v_exp_f32 v119, v119
  v_mfma_f32_16x16x32_bf16 v[100:103], a[88:91], a[24:27], v[100:103]
  ds_read_b64_tr_b16 a[250:251], v20 offset:8904
  v_cvt_pk_bf16_f32 v44, v120, v121
  v_mfma_f32_16x16x32_bf16 v[100:103], a[84:87], a[20:23], v[100:103]
  ds_read_b64_tr_b16 a[170:171], v13 offset:576
  v_cvt_pk_bf16_f32 v45, v122, v123
  v_mfma_f32_16x16x32_bf16 v[100:103], a[80:83], a[16:19], v[100:103]
  v_cvt_pk_bf16_f32 v40, v112, v113
  v_cvt_pk_bf16_f32 v41, v114, v115
  v_cvt_pk_bf16_f32 v42, v116, v117
  v_cvt_pk_bf16_f32 v43, v118, v119
  ds_read_b64_tr_b16 a[168:169], v13 offset:64
  ds_read_b64_tr_b16 a[174:175], v13 offset:584
  v_smfmac_f32_16x16x64_bf16 v[80:83], v[36:39], v[40:47], v35
  s_waitcnt lgkmcnt(4)
  v_add_f32 v120, v52, v8
  v_add_f32 v121, v52, v9
  v_mfma_f32_16x16x32_bf16 v[128:131], a[160:163], v[40:43], v[128:131]
  ds_read_b64_tr_b16 a[172:173], v13 offset:72
  ds_read_b64_tr_b16 a[244:245], v20 offset:8832
  v_mfma_f32_16x16x32_bf16 v[132:135], a[164:167], v[40:43], v[132:135]
  v_add_f32 v122, v52, v10
  v_add_f32 v123, v52, v11
  v_mfma_f32_16x16x16_bf16 v[128:131], a[240:241], v[44:45], v[128:131]
  ds_read_b64_tr_b16 a[246:247], v20 offset:8840
  ds_read_b64_tr_b16 a[186:187], v13 offset:704
  v_mfma_f32_16x16x16_bf16 v[132:135], a[242:243], v[44:45], v[132:135]
  v_add_f32 v80, v80, v81
  v_add_f32 v82, v82, v83
  v_mfma_f32_16x16x32_bf16 v[144:147], a[176:179], v[40:43], v[144:147]
  ds_read_b64_tr_b16 a[184:185], v13 offset:192
  ds_read_b64_tr_b16 a[190:191], v13 offset:712
  v_mfma_f32_16x16x32_bf16 v[148:151], a[180:183], v[40:43], v[148:151]
  v_exp_f32 v96, v96
  v_mfma_f32_16x16x16_bf16 v[144:147], a[248:249], v[44:45], v[144:147]
  s_waitcnt lgkmcnt(5)
  ds_read_b64_tr_b16 a[188:189], v13 offset:200
  ds_read_b64_tr_b16 a[252:253], v20 offset:8960
  v_mfma_f32_16x16x16_bf16 v[148:151], a[250:251], v[44:45], v[148:151]
  v_exp_f32 v97, v97
  v_mfma_f32_16x16x32_bf16 v[136:139], a[168:171], v[40:43], v[136:139]
  ds_read_b64_tr_b16 a[254:255], v20 offset:8968
  v_add_f32 v80, v80, v82
  v_mfma_f32_16x16x32_bf16 v[140:143], a[172:175], v[40:43], v[140:143]
  s_waitcnt lgkmcnt(5)
  v_rcp_f32 v2, v80
  v_mfma_f32_16x16x16_bf16 v[136:139], a[244:245], v[44:45], v[136:139]
  ds_read_b128 a[64:67], v12 offset:0
  v_mul_f32 v16, v16, v2
  v_mfma_f32_16x16x16_bf16 v[140:143], a[246:247], v[44:45], v[140:143]
  s_waitcnt lgkmcnt(4)
  ds_read_b128 a[68:71], v12 offset:64
  v_fma_f32 v128, v128, v2, v16
  v_mfma_f32_16x16x32_bf16 v[152:155], a[184:187], v[40:43], v[152:155]
  v_fma_f32 v129, v129, v2, v16
  v_fma_f32 v130, v130, v2, v16
  v_fma_f32 v131, v131, v2, v16
  v_cvt_pk_bf16_f32 v128, v128, v129
  v_fma_f32 v132, v132, v2, v16
  v_fma_f32 v133, v133, v2, v16
  v_fma_f32 v134, v134, v2, v16
  v_fma_f32 v135, v135, v2, v16
  v_cvt_pk_bf16_f32 v129, v130, v131
  v_cvt_pk_bf16_f32 v130, v132, v133
  v_cvt_pk_bf16_f32 v131, v134, v135
  s_waitcnt lgkmcnt(2)
  v_mfma_f32_16x16x32_bf16 v[156:159], a[188:191], v[40:43], v[156:159]
  buffer_store_dwordx4 v[128:131], v24, s[28:31], s60 offen offset:0 sc1
  v_fma_f32 v144, v144, v2, v16
  v_fma_f32 v145, v145, v2, v16
  v_fma_f32 v146, v146, v2, v16
  v_mfma_f32_16x16x16_bf16 v[152:155], a[252:253], v[44:45], v[152:155]
  ds_read_b128 a[72:75], v12 offset:128
  v_fma_f32 v147, v147, v2, v16
  v_mfma_f32_16x16x16_bf16 v[156:159], a[254:255], v[44:45], v[156:159]
  ds_read_b128 a[76:79], v12 offset:192
  v_cvt_pk_bf16_f32 v144, v144, v145
  v_mfma_f32_16x16x32_bf16 v[104:107], a[96:99], a[16:19], v[52:55]
  ds_read_b128 a[92:95], v12 offset:704
  v_fma_f32 v148, v148, v2, v16
  v_mfma_f32_16x16x32_bf16 v[104:107], a[100:103], a[20:23], v[104:107]
  ds_read_b128 a[88:91], v12 offset:640
  v_fma_f32 v149, v149, v2, v16
  v_mfma_f32_16x16x32_bf16 v[104:107], a[104:107], a[24:27], v[104:107]
  ds_read_b128 a[84:87], v12 offset:576
  v_fma_f32 v150, v150, v2, v16
  v_mfma_f32_16x16x32_bf16 v[104:107], a[108:111], a[28:31], v[104:107]
  ds_read_b128 a[80:83], v12 offset:512
  v_fma_f32 v151, v151, v2, v16
  v_mfma_f32_16x16x32_bf16 v[108:111], a[124:127], a[28:31], v[52:55]
  v_cvt_pk_bf16_f32 v145, v146, v147
  v_cvt_pk_bf16_f32 v146, v148, v149
  v_mfma_f32_16x16x32_bf16 v[108:111], a[120:123], a[24:27], v[108:111]
L_st3:
  s_cbranch_vccnz L_stret
  v_cvt_pk_bf16_f32 v147, v150, v151
  v_cvt_pk_bf16_f32 v64, v96, v97
  v_mfma_f32_16x16x32_bf16 v[108:111], a[116:119], a[20:23], v[108:111]
  v_exp_f32 v98, v98
  v_mfma_f32_16x16x32_bf16 v[108:111], a[112:115], a[16:19], v[108:111]
  v_exp_f32 v99, v99
  v_exp_f32 v100, v100
  v_cvt_pk_bf16_f32 v65, v98, v99
  v_pk_fma_f32 v[152:153], v[152:153], v[2:3], v[16:17] op_sel_hi:[1,0,0]
  v_pk_fma_f32 v[154:155], v[154:155], v[2:3], v[16:17] op_sel_hi:[1,0,0]
  v_pk_fma_f32 v[156:157], v[156:157], v[2:3], v[16:17] op_sel_hi:[1,0,0]
  v_pk_fma_f32 v[158:159], v[158:159], v[2:3], v[16:17] op_sel_hi:[1,0,0]
  v_mfma_f32_16x16x32_bf16 v[120:123], a[224:227], a[16:19], v[120:123]
  v_exp_f32 v101, v101
  v_mfma_f32_16x16x32_bf16 v[120:123], a[228:231], a[20:23], v[120:123]
  buffer_store_dwordx4 v[144:147], v24, s[28:31], s60 offen offset:128 sc1
  v_exp_f32 v102, v102
  v_cvt_pk_bf16_f32 v66, v100, v101
  v_mfma_f32_16x16x32_bf16 v[120:123], a[232:235], a[24:27], v[120:123]
  v_exp_f32 v103, v103
  v_mfma_f32_16x16x32_bf16 v[120:123], a[236:239], a[28:31], v[120:123]
  s_waitcnt lgkmcnt(0)
  v_cvt_pk_bf16_f32 v67, v102, v103
  v_fma_f32 v136, v136, v2, v16
  v_mfma_f32_16x16x32_bf16 v[112:115], a[64:67], a[16:19], v[52:55]
  v_exp_f32 v104, v104
  v_mfma_f32_16x16x32_bf16 v[112:115], a[68:71], a[20:23], v[112:115]
  v_exp_f32 v105, v105
  v_mfma_f32_16x16x32_bf16 v[112:115], a[72:75], a[24:27], v[112:115]
  v_exp_f32 v106, v106
  v_mfma_f32_16x16x32_bf16 v[112:115], a[76:79], a[28:31], v[112:115]
  v_exp_f32 v107, v107
  v_mfma_f32_16x16x32_bf16 v[116:119], a[92:95], a[28:31], v[52:55]
  v_exp_f32 v108, v108
  v_mfma_f32_16x16x32_bf16 v[116:119], a[88:91], a[24:27], v[116:119]
  v_exp_f32 v109, v109
  v_mfma_f32_16x16x32_bf16 v[116:119], a[84:87], a[20:23], v[116:119]
  v_exp_f32 v110, v110
  v_mfma_f32_16x16x32_bf16 v[116:119], a[80:83], a[16:19], v[116:119]
  v_exp_f32 v111, v111
  v_mfma_f32_16x16x32_bf16 v[160:163], a[160:163], v[64:67], v[160:163]
  v_cvt_pk_bf16_f32 v68, v104, v105
  v_cvt_pk_bf16_f32 v69, v106, v107
  v_cvt_pk_bf16_f32 v70, v108, v109
  v_cvt_pk_bf16_f32 v71, v110, v111
  v_fma_f32 v137, v137, v2, v16
  v_fma_f32 v138, v138, v2, v16
  v_mfma_f32_16x16x32_bf16 v[160:163], a[128:131], v[68:71], v[160:163]
  v_fma_f32 v139, v139, v2, v16
  v_cvt_pk_bf16_f32 v136, v136, v137
  v_mfma_f32_16x16x32_bf16 v[164:167], a[132:135], v[68:71], v[164:167]
  v_fma_f32 v140, v140, v2, v16
  v_fma_f32 v141, v141, v2, v16
  v_mfma_f32_16x16x32_bf16 v[164:167], a[164:167], v[64:67], v[164:167]
  v_fma_f32 v142, v142, v2, v16
  v_fma_f32 v143, v143, v2, v16
  v_mfma_f32_16x16x32_bf16 v[168:171], a[168:171], v[64:67], v[168:171]
  v_cvt_pk_bf16_f32 v137, v138, v139
  v_cvt_pk_bf16_f32 v138, v140, v141
  v_cvt_pk_bf16_f32 v139, v142, v143
  v_mfma_f32_16x16x32_bf16 v[168:171], a[136:139], v[68:71], v[168:171]
  buffer_store_dwordx4 v[136:139], v24, s[28:31], s60 offen offset:64 sc1
  v_cvt_pk_bf16_f32 v152, v152, v153
  v_cvt_pk_bf16_f32 v153, v154, v155
  v_cvt_pk_bf16_f32 v154, v156, v157
  v_mfma_f32_16x16x32_bf16 v[172:175], a[140:143], v[68:71], v[172:175]
  v_exp_f32 v120, v120
  v_mfma_f32_16x16x32_bf16 v[172:175], a[172:175], v[64:67], v[172:175]
  v_exp_f32 v121, v121
  v_mfma_f32_16x16x32_bf16 v[176:179], a[176:179], v[64:67], v[176:179]
  v_cvt_pk_bf16_f32 v155, v158, v159
  v_cvt_pk_bf16_f32 v44, v120, v121
  v_mfma_f32_16x16x32_bf16 v[176:179], a[144:147], v[68:71], v[176:179]
  v_exp_f32 v122, v122
  v_mfma_f32_16x16x32_bf16 v[180:183], a[148:151], v[68:71], v[180:183]
  v_exp_f32 v123, v123
  v_mfma_f32_16x16x32_bf16 v[180:183], a[180:183], v[64:67], v[180:183]
  v_exp_f32 v112, v112
  v_mfma_f32_16x16x32_bf16 v[184:187], a[184:187], v[64:67], v[184:187]
  v_exp_f32 v113, v113
  v_mfma_f32_16x16x32_bf16 v[184:187], a[152:155], v[68:71], v[184:187]
  v_exp_f32 v114, v114
  v_mfma_f32_16x16x32_bf16 v[188:191], a[156:159], v[68:71], v[188:191]
  v_exp_f32 v115, v115
  v_mfma_f32_16x16x32_bf16 v[188:191], a[188:191], v[64:67], v[188:191]
  v_exp_f32 v116, v116
  v_smfmac_f32_16x16x64_bf16 v[84:87], v[36:39], v[64:71], v35
  v_exp_f32 v117, v117
  v_mfma_f32_16x16x32_bf16 v[96:99], a[64:67], a[32:35], v[56:59]
  v_exp_f32 v118, v118
  v_mfma_f32_16x16x32_bf16 v[96:99], a[68:71], a[36:39], v[96:99]
  buffer_store_dwordx4 v[152:155], v24, s[28:31], s60 offen offset:192 sc1
  v_exp_f32 v119, v119
  v_cvt_pk_bf16_f32 v45, v122, v123
  v_mfma_f32_16x16x32_bf16 v[96:99], a[72:75], a[40:43], v[96:99]
  ds_read_b128 a[64:67], v34 offset:0
  v_cvt_pk_bf16_f32 v40, v112, v113
  v_mfma_f32_16x16x32_bf16 v[96:99], a[76:79], a[44:47], v[96:99]
  ds_read_b128 a[68:71], v34 offset:64
  v_cvt_pk_bf16_f32 v41, v114, v115
  v_mfma_f32_16x16x32_bf16 v[100:103], a[92:95], a[44:47], v[56:59]
  ds_read_b128 a[72:75], v34 offset:128
  v_cvt_pk_bf16_f32 v42, v116, v117
  v_mfma_f32_16x16x32_bf16 v[100:103], a[88:91], a[40:43], v[100:103]
  ds_read_b128 a[76:79], v34 offset:192
  v_cvt_pk_bf16_f32 v43, v118, v119
  v_mfma_f32_16x16x32_bf16 v[100:103], a[84:87], a[36:39], v[100:103]
  ds_read_b128 a[92:95], v34 offset:704
  v_add_f32 v120, v56, v8
  v_mfma_f32_16x16x32_bf16 v[100:103], a[80:83], a[32:35], v[100:103]
  ds_read_b128 a[88:91], v34 offset:640
  v_add_f32 v121, v56, v9
  v_smfmac_f32_16x16x64_bf16 v[84:87], v[36:39], v[40:47], v35
  ds_read_b128 a[84:87], v34 offset:576
  v_add_f32 v122, v56, v10
  v_mfma_f32_16x16x32_bf16 v[160:163], a[192:195], v[40:43], v[160:163]
  ds_read_b128 a[80:83], v34 offset:512
  v_add_f32 v123, v56, v11
  v_mfma_f32_16x16x32_bf16 v[164:167], a[196:199], v[40:43], v[164:167]
  v_exp_f32 v96, v96
  v_mfma_f32_16x16x16_bf16 v[160:163], a[240:241], v[44:45], v[160:163]
  v_add_f32 v84, v84, v85
  v_add_f32 v86, v86, v87
  v_mfma_f32_16x16x16_bf16 v[164:167], a[242:243], v[44:45], v[164:167]
  v_exp_f32 v97, v97
  v_mfma_f32_16x16x32_bf16 v[176:179], a[208:211], v[40:43], v[176:179]
  v_add_f32 v84, v84, v86
  v_cvt_pk_bf16_f32 v64, v96, v97
  v_mfma_f32_16x16x32_bf16 v[180:183], a[212:215], v[40:43], v[180:183]
  v_rcp_f32 v3, v84
  v_mfma_f32_16x16x16_bf16 v[176:179], a[248:249], v[44:45], v[176:179]
  v_mul_f32 v17, v17, v3
  v_fma_f32 v160, v160, v3, v17
  v_mfma_f32_16x16x16_bf16 v[180:183], a[250:251], v[44:45], v[180:183]
  v_fma_f32 v161, v161, v3, v17
  v_fma_f32 v162, v162, v3, v17
  v_mfma_f32_16x16x32_bf16 v[168:171], a[200:203], v[40:43], v[168:171]
  v_fma_f32 v163, v163, v3, v17
  v_cvt_pk_bf16_f32 v160, v160, v161
  v_mfma_f32_16x16x32_bf16 v[172:175], a[204:207], v[40:43], v[172:175]
  v_fma_f32 v164, v164, v3, v17
  v_fma_f32 v165, v165, v3, v17
  v_mfma_f32_16x16x16_bf16 v[168:171], a[244:245], v[44:45], v[168:171]
  v_fma_f32 v166, v166, v3, v17
  v_fma_f32 v167, v167, v3, v17
  v_mfma_f32_16x16x16_bf16 v[172:175], a[246:247], v[44:45], v[172:175]
  v_cvt_pk_bf16_f32 v161, v162, v163
  v_cvt_pk_bf16_f32 v162, v164, v165
  v_mfma_f32_16x16x32_bf16 v[184:187], a[216:219], v[40:43], v[184:187]
L_st4:
  s_cbranch_vccnz L_stret
  v_cvt_pk_bf16_f32 v163, v166, v167
  v_mfma_f32_16x16x32_bf16 v[188:191], a[220:223], v[40:43], v[188:191]
  buffer_store_dwordx4 v[160:163], v24, s[28:31], s61 offen offset:0 sc1
  v_fma_f32 v176, v176, v3, v17
  v_fma_f32 v177, v177, v3, v17
  v_fma_f32 v178, v178, v3, v17
  v_mfma_f32_16x16x16_bf16 v[184:187], a[252:253], v[44:45], v[184:187]
  v_fma_f32 v179, v179, v3, v17
  v_cvt_pk_bf16_f32 v176, v176, v177
  v_mfma_f32_16x16x16_bf16 v[188:191], a[254:255], v[44:45], v[188:191]
  v_fma_f32 v180, v180, v3, v17
  v_fma_f32 v181, v181, v3, v17
  v_mfma_f32_16x16x32_bf16 v[104:107], a[96:99], a[32:35], v[56:59]
  v_fma_f32 v182, v182, v3, v17
  v_fma_f32 v183, v183, v3, v17
  v_mfma_f32_16x16x32_bf16 v[104:107], a[100:103], a[36:39], v[104:107]
  v_cvt_pk_bf16_f32 v177, v178, v179
  v_cvt_pk_bf16_f32 v178, v180, v181
  v_mfma_f32_16x16x32_bf16 v[104:107], a[104:107], a[40:43], v[104:107]
  v_cvt_pk_bf16_f32 v179, v182, v183
  v_fma_f32 v168, v168, v3, v17
  v_mfma_f32_16x16x32_bf16 v[104:107], a[108:111], a[44:47], v[104:107]
  v_exp_f32 v98, v98
  v_mfma_f32_16x16x32_bf16 v[108:111], a[124:127], a[44:47], v[56:59]
  v_exp_f32 v99, v99
  v_mfma_f32_16x16x32_bf16 v[108:111], a[120:123], a[40:43], v[108:111]
  v_exp_f32 v100, v100
  v_mfma_f32_16x16x32_bf16 v[108:111], a[116:119], a[36:39], v[108:111]
  v_exp_f32 v101, v101
  v_mfma_f32_16x16x32_bf16 v[108:111], a[112:115], a[32:35], v[108:111]
  v_exp_f32 v102, v102
  v_exp_f32 v103, v103
  v_cvt_pk_bf16_f32 v65, v98, v99
  v_pk_fma_f32 v[184:185], v[184:185], v[2:3], v[16:17] op_sel:[0,1,1] op_sel_hi:[1,1,1]
  v_pk_fma_f32 v[186:187], v[186:187], v[2:3], v[16:17] op_sel:[0,1,1] op_sel_hi:[1,1,1]
  v_pk_fma_f32 v[188:189], v[188:189], v[2:3], v[16:17] op_sel:[0,1,1] op_sel_hi:[1,1,1]
  v_pk_fma_f32 v[190:191], v[190:191], v[2:3], v[16:17] op_sel:[0,1,1] op_sel_hi:[1,1,1]
  v_mfma_f32_16x16x32_bf16 v[120:123], a[224:227], a[32:35], v[120:123]
  v_cvt_pk_bf16_f32 v66, v100, v101
  v_cvt_pk_bf16_f32 v67, v102, v103
  v_mfma_f32_16x16x32_bf16 v[120:123], a[228:231], a[36:39], v[120:123]
  buffer_store_dwordx4 v[176:179], v24, s[28:31], s61 offen offset:128 sc1
  v_exp_f32 v104, v104
  v_fma_f32 v169, v169, v3, v17
  v_mfma_f32_16x16x32_bf16 v[120:123], a[232:235], a[40:43], v[120:123]
  v_exp_f32 v105, v105
  v_mfma_f32_16x16x32_bf16 v[120:123], a[236:239], a[44:47], v[120:123]
  s_waitcnt lgkmcnt(0)
  v_exp_f32 v106, v106
  v_mfma_f32_16x16x32_bf16 v[112:115], a[64:67], a[32:35], v[56:59]
  v_exp_f32 v107, v107
  v_mfma_f32_16x16x32_bf16 v[112:115], a[68:71], a[36:39], v[112:115]
  v_exp_f32 v108, v108
  v_mfma_f32_16x16x32_bf16 v[112:115], a[72:75], a[40:43], v[112:115]
  v_exp_f32 v109, v109
  v_mfma_f32_16x16x32_bf16 v[112:115], a[76:79], a[44:47], v[112:115]
  v_exp_f32 v110, v110
  v_mfma_f32_16x16x32_bf16 v[116:119], a[92:95], a[44:47], v[56:59]
  v_exp_f32 v111, v111
  v_mfma_f32_16x16x32_bf16 v[116:119], a[88:91], a[40:43], v[116:119]
  v_fma_f32 v170, v170, v3, v17
  v_fma_f32 v171, v171, v3, v17
  v_mfma_f32_16x16x32_bf16 v[116:119], a[84:87], a[36:39], v[116:119]
  v_cvt_pk_bf16_f32 v168, v168, v169
  v_cvt_pk_bf16_f32 v68, v104, v105
  v_mfma_f32_16x16x32_bf16 v[116:119], a[80:83], a[32:35], v[116:119]
  v_cvt_pk_bf16_f32 v69, v106, v107
  v_cvt_pk_bf16_f32 v70, v108, v109
  v_mfma_f32_16x16x32_bf16 v[192:195], a[192:195], v[64:67], v[192:195]
  v_cvt_pk_bf16_f32 v71, v110, v111
  v_fma_f32 v172, v172, v3, v17
  v_fma_f32 v173, v173, v3, v17
  v_mfma_f32_16x16x32_bf16 v[192:195], a[128:131], v[68:71], v[192:195]
  v_fma_f32 v174, v174, v3, v17
  v_fma_f32 v175, v175, v3, v17
  v_mfma_f32_16x16x32_bf16 v[196:199], a[132:135], v[68:71], v[196:199]
  v_cvt_pk_bf16_f32 v169, v170, v171
  v_cvt_pk_bf16_f32 v170, v172, v173
  v_cvt_pk_bf16_f32 v171, v174, v175
  v_mfma_f32_16x16x32_bf16 v[196:199], a[196:199], v[64:67], v[196:199]
  buffer_store_dwordx4 v[168:171], v24, s[28:31], s61 offen offset:64 sc1
  v_cvt_pk_bf16_f32 v184, v184, v185
  v_cvt_pk_bf16_f32 v185, v186, v187
  v_cvt_pk_bf16_f32 v186, v188, v189
  v_mfma_f32_16x16x32_bf16 v[200:203], a[200:203], v[64:67], v[200:203]
  v_exp_f32 v120, v120
  v_mfma_f32_16x16x32_bf16 v[200:203], a[136:139], v[68:71], v[200:203]
  v_exp_f32 v121, v121
  v_mfma_f32_16x16x32_bf16 v[204:207], a[140:143], v[68:71], v[204:207]
  v_cvt_pk_bf16_f32 v187, v190, v191
  v_cvt_pk_bf16_f32 v44, v120, v121
  v_mfma_f32_16x16x32_bf16 v[204:207], a[204:207], v[64:67], v[204:207]
  v_exp_f32 v122, v122
  v_mfma_f32_16x16x32_bf16 v[208:211], a[208:211], v[64:67], v[208:211]
  v_exp_f32 v123, v123
  v_mfma_f32_16x16x32_bf16 v[208:211], a[144:147], v[68:71], v[208:211]
  v_exp_f32 v112, v112
  v_mfma_f32_16x16x32_bf16 v[212:215], a[148:151], v[68:71], v[212:215]
  v_exp_f32 v113, v113
  v_mfma_f32_16x16x32_bf16 v[212:215], a[212:215], v[64:67], v[212:215]
  v_exp_f32 v114, v114
  v_mfma_f32_16x16x32_bf16 v[216:219], a[216:219], v[64:67], v[216:219]
  v_exp_f32 v115, v115
  v_mfma_f32_16x16x32_bf16 v[216:219], a[152:155], v[68:71], v[216:219]
  v_exp_f32 v116, v116
  v_mfma_f32_16x16x32_bf16 v[220:223], a[156:159], v[68:71], v[220:223]
  v_exp_f32 v117, v117
  v_mfma_f32_16x16x32_bf16 v[220:223], a[220:223], v[64:67], v[220:223]
  v_exp_f32 v118, v118
  v_smfmac_f32_16x16x64_bf16 v[88:91], v[36:39], v[64:71], v35
  buffer_store_dwordx4 v[184:187], v24, s[28:31], s61 offen offset:192 sc1
  v_exp_f32 v119, v119
  v_cvt_pk_bf16_f32 v45, v122, v123
  v_mfma_f32_16x16x32_bf16 v[96:99], a[64:67], a[48:51], v[60:63]
  v_cvt_pk_bf16_f32 v40, v112, v113
  v_cvt_pk_bf16_f32 v41, v114, v115
  v_mfma_f32_16x16x32_bf16 v[96:99], a[68:71], a[52:55], v[96:99]
  ds_read_b128 a[64:67], v12 offset:0
  v_cvt_pk_bf16_f32 v42, v116, v117
  v_mfma_f32_16x16x32_bf16 v[96:99], a[72:75], a[56:59], v[96:99]
  ds_read_b128 a[68:71], v12 offset:64
  v_cvt_pk_bf16_f32 v43, v118, v119
  v_mfma_f32_16x16x32_bf16 v[96:99], a[76:79], a[60:63], v[96:99]
  ds_read_b128 a[72:75], v12 offset:128
  v_add_f32 v120, v60, v8
  v_mfma_f32_16x16x32_bf16 v[100:103], a[92:95], a[60:63], v[60:63]
  ds_read_b128 a[76:79], v12 offset:192
  v_add_f32 v121, v60, v9
  v_mfma_f32_16x16x32_bf16 v[100:103], a[88:91], a[56:59], v[100:103]
  ds_read_b128 a[92:95], v12 offset:704
  v_add_f32 v122, v60, v10
  v_mfma_f32_16x16x32_bf16 v[100:103], a[84:87], a[52:55], v[100:103]
  ds_read_b128 a[88:91], v12 offset:640
  v_add_f32 v123, v60, v11
  v_mfma_f32_16x16x32_bf16 v[100:103], a[80:83], a[48:51], v[100:103]
  v_exp_f32 v96, v96
  v_smfmac_f32_16x16x64_bf16 v[88:91], v[36:39], v[40:47], v35
  ds_read_b128 a[84:87], v12 offset:576
  ds_read_b128 a[80:83], v12 offset:512
  v_mfma_f32_16x16x32_bf16 v[192:195], a[160:163], v[40:43], v[192:195]
  v_exp_f32 v97, v97
  v_mfma_f32_16x16x32_bf16 v[196:199], a[164:167], v[40:43], v[196:199]
  v_exp_f32 v98, v98
  v_mfma_f32_16x16x16_bf16 v[192:195], a[240:241], v[44:45], v[192:195]
  v_exp_f32 v99, v99
  v_mfma_f32_16x16x16_bf16 v[196:199], a[242:243], v[44:45], v[196:199]
  v_add_f32 v88, v88, v89
  v_add_f32 v90, v90, v91
  v_mfma_f32_16x16x32_bf16 v[208:211], a[176:179], v[40:43], v[208:211]
  v_add_f32 v88, v88, v90
  v_cvt_pk_bf16_f32 v64, v96, v97
  v_mfma_f32_16x16x32_bf16 v[212:215], a[180:183], v[40:43], v[212:215]
  v_rcp_f32 v4, v88
  v_mfma_f32_16x16x16_bf16 v[208:211], a[248:249], v[44:45], v[208:211]
  v_mul_f32 v18, v18, v4
  v_fma_f32 v192, v192, v4, v18
  v_mfma_f32_16x16x16_bf16 v[212:215], a[250:251], v[44:45], v[212:215]
  v_fma_f32 v193, v193, v4, v18
  v_fma_f32 v194, v194, v4, v18
  v_mfma_f32_16x16x32_bf16 v[200:203], a[168:171], v[40:43], v[200:203]
L_st5:
  s_cbranch_vccnz L_stret
  v_fma_f32 v195, v195, v4, v18
  v_cvt_pk_bf16_f32 v192, v192, v193
  v_mfma_f32_16x16x32_bf16 v[204:207], a[172:175], v[40:43], v[204:207]
  v_fma_f32 v196, v196, v4, v18
  v_fma_f32 v197, v197, v4, v18
  v_mfma_f32_16x16x16_bf16 v[200:203], a[244:245], v[44:45], v[200:203]
  v_fma_f32 v198, v198, v4, v18
  v_fma_f32 v199, v199, v4, v18
  v_mfma_f32_16x16x16_bf16 v[204:207], a[246:247], v[44:45], v[204:207]
  v_cvt_pk_bf16_f32 v193, v194, v195
  v_cvt_pk_bf16_f32 v194, v196, v197
  v_mfma_f32_16x16x32_bf16 v[216:219], a[184:187], v[40:43], v[216:219]
  v_cvt_pk_bf16_f32 v195, v198, v199
  v_mfma_f32_16x16x32_bf16 v[220:223], a[188:191], v[40:43], v[220:223]
  buffer_store_dwordx4 v[192:195], v24, s[28:31], s62 offen offset:0 sc1
  v_fma_f32 v208, v208, v4, v18
  v_fma_f32 v209, v209, v4, v18
  v_fma_f32 v210, v210, v4, v18
  v_mfma_f32_16x16x16_bf16 v[216:219], a[252:253], v[44:45], v[216:219]
  v_fma_f32 v211, v211, v4, v18
  v_cvt_pk_bf16_f32 v208, v208, v209
  v_mfma_f32_16x16x16_bf16 v[220:223], a[254:255], v[44:45], v[220:223]
  v_fma_f32 v212, v212, v4, v18
  v_fma_f32 v213, v213, v4, v18
  v_mfma_f32_16x16x32_bf16 v[104:107], a[96:99], a[48:51], v[60:63]
  v_fma_f32 v214, v214, v4, v18
  v_fma_f32 v215, v215, v4, v18
  v_mfma_f32_16x16x32_bf16 v[104:107], a[100:103], a[52:55], v[104:107]
  v_cvt_pk_bf16_f32 v209, v210, v211
  v_cvt_pk_bf16_f32 v210, v212, v213
  v_mfma_f32_16x16x32_bf16 v[104:107], a[104:107], a[56:59], v[104:107]
  v_cvt_pk_bf16_f32 v211, v214, v215
  v_cvt_pk_bf16_f32 v65, v98, v99
  v_mfma_f32_16x16x32_bf16 v[104:107], a[108:111], a[60:63], v[104:107]
  v_exp_f32 v100, v100
  v_mfma_f32_16x16x32_bf16 v[108:111], a[124:127], a[60:63], v[60:63]
  v_exp_f32 v101, v101
  v_mfma_f32_16x16x32_bf16 v[108:111], a[120:123], a[56:59], v[108:111]
  v_exp_f32 v102, v102
  v_mfma_f32_16x16x32_bf16 v[108:111], a[116:119], a[52:55], v[108:111]
  v_exp_f32 v103, v103
  v_mfma_f32_16x16x32_bf16 v[108:111], a[112:115], a[48:51], v[108:111]
  v_cvt_pk_bf16_f32 v66, v100, v101
  v_cvt_pk_bf16_f32 v67, v102, v103
  v_mfma_f32_16x16x32_bf16 v[120:123], a[224:227], a[48:51], v[120:123]
  v_exp_f32 v104, v104
  v_mfma_f32_16x16x32_bf16 v[120:123], a[228:231], a[52:55], v[120:123]
  v_exp_f32 v105, v105
  v_mfma_f32_16x16x32_bf16 v[120:123], a[232:235], a[56:59], v[120:123]
  buffer_store_dwordx4 v[208:211], v24, s[28:31], s62 offen offset:128 sc1
  v_exp_f32 v106, v106
  v_cvt_pk_bf16_f32 v68, v104, v105
  v_mfma_f32_16x16x32_bf16 v[120:123], a[236:239], a[60:63], v[120:123]
  s_waitcnt lgkmcnt(0)
  v_exp_f32 v107, v107
  v_mfma_f32_16x16x32_bf16 v[112:115], a[64:67], a[48:51], v[60:63]
  v_exp_f32 v108, v108
  v_mfma_f32_16x16x32_bf16 v[112:115], a[68:71], a[52:55], v[112:115]
  v_exp_f32 v109, v109
  v_mfma_f32_16x16x32_bf16 v[112:115], a[72:75], a[56:59], v[112:115]
  v_exp_f32 v110, v110
  v_mfma_f32_16x16x32_bf16 v[112:115], a[76:79], a[60:63], v[112:115]
  v_exp_f32 v111, v111
  v_mfma_f32_16x16x32_bf16 v[116:119], a[92:95], a[60:63], v[60:63]
  v_cvt_pk_bf16_f32 v69, v106, v107
  v_cvt_pk_bf16_f32 v70, v108, v109
  v_mfma_f32_16x16x32_bf16 v[116:119], a[88:91], a[56:59], v[116:119]
  v_cvt_pk_bf16_f32 v71, v110, v111
  v_fma_f32 v200, v200, v4, v18
  v_mfma_f32_16x16x32_bf16 v[116:119], a[84:87], a[52:55], v[116:119]
  v_fma_f32 v201, v201, v4, v18
  v_fma_f32 v202, v202, v4, v18
  v_mfma_f32_16x16x32_bf16 v[116:119], a[80:83], a[48:51], v[116:119]
  v_fma_f32 v203, v203, v4, v18
  v_cvt_pk_bf16_f32 v200, v200, v201
  v_mfma_f32_16x16x32_bf16 v[224:227], a[160:163], v[64:67], v[224:227]
  v_fma_f32 v204, v204, v4, v18
  v_fma_f32 v205, v205, v4, v18
  v_mfma_f32_16x16x32_bf16 v[224:227], a[128:131], v[68:71], v[224:227]
  v_fma_f32 v206, v206, v4, v18
  v_fma_f32 v207, v207, v4, v18
  v_mfma_f32_16x16x32_bf16 v[228:231], a[132:135], v[68:71], v[228:231]
  v_cvt_pk_bf16_f32 v201, v202, v203
  v_cvt_pk_bf16_f32 v202, v204, v205
  v_mfma_f32_16x16x32_bf16 v[228:231], a[164:167], v[64:67], v[228:231]
  v_cvt_pk_bf16_f32 v203, v206, v207
  v_fma_f32 v216, v216, v4, v18
  v_mfma_f32_16x16x32_bf16 v[232:235], a[168:171], v[64:67], v[232:235]
  buffer_store_dwordx4 v[200:203], v24, s[28:31], s62 offen offset:64 sc1
  v_exp_f32 v120, v120
  v_fma_f32 v217, v217, v4, v18
  v_mfma_f32_16x16x32_bf16 v[232:235], a[136:139], v[68:71], v[232:235]
  v_exp_f32 v121, v121
  v_mfma_f32_16x16x32_bf16 v[236:239], a[140:143], v[68:71], v[236:239]
  v_exp_f32 v122, v122
  v_mfma_f32_16x16x32_bf16 v[236:239], a[172:175], v[64:67], v[236:239]
  v_exp_f32 v123, v123
  v_mfma_f32_16x16x32_bf16 v[240:243], a[176:179], v[64:67], v[240:243]
  v_exp_f32 v112, v112
  v_mfma_f32_16x16x32_bf16 v[240:243], a[144:147], v[68:71], v[240:243]
  v_exp_f32 v113, v113
  v_mfma_f32_16x16x32_bf16 v[244:247], a[148:151], v[68:71], v[244:247]
  v_exp_f32 v114, v114
  v_mfma_f32_16x16x32_bf16 v[244:247], a[180:183], v[64:67], v[244:247]
  v_exp_f32 v115, v115
  v_mfma_f32_16x16x32_bf16 v[248:251], a[184:187], v[64:67], v[248:251]
  v_exp_f32 v116, v116
  v_mfma_f32_16x16x32_bf16 v[248:251], a[152:155], v[68:71], v[248:251]
  v_exp_f32 v117, v117
  v_mfma_f32_16x16x32_bf16 v[252:255], a[156:159], v[68:71], v[252:255]
  v_exp_f32 v118, v118
  v_mfma_f32_16x16x32_bf16 v[252:255], a[188:191], v[64:67], v[252:255]
  v_exp_f32 v119, v119
  v_smfmac_f32_16x16x64_bf16 v[92:95], v[36:39], v[64:71], v35
  v_cvt_pk_bf16_f32 v44, v120, v121
  v_cvt_pk_bf16_f32 v45, v122, v123
  v_cvt_pk_bf16_f32 v40, v112, v113
  v_cvt_pk_bf16_f32 v41, v114, v115
  v_cvt_pk_bf16_f32 v42, v116, v117
  v_cvt_pk_bf16_f32 v43, v118, v119
  v_fma_f32 v218, v218, v4, v18
  v_fma_f32 v219, v219, v4, v18
  v_smfmac_f32_16x16x64_bf16 v[92:95], v[36:39], v[40:47], v35
  v_cvt_pk_bf16_f32 v216, v216, v217
  v_fma_f32 v220, v220, v4, v18
  v_mfma_f32_16x16x32_bf16 v[224:227], a[192:195], v[40:43], v[224:227]
  v_fma_f32 v221, v221, v4, v18
  v_fma_f32 v222, v222, v4, v18
  v_fma_f32 v223, v223, v4, v18
  v_cvt_pk_bf16_f32 v217, v218, v219
  v_cvt_pk_bf16_f32 v218, v220, v221
  v_cvt_pk_bf16_f32 v219, v222, v223
  v_mfma_f32_16x16x32_bf16 v[228:231], a[196:199], v[40:43], v[228:231]
  buffer_store_dwordx4 v[216:219], v24, s[28:31], s62 offen offset:192 sc1
  v_add_f32 v92, v92, v93
  v_add_f32 v94, v94, v95
  v_add_f32 v92, v92, v94
  v_mfma_f32_16x16x16_bf16 v[224:227], a[240:241], v[44:45], v[224:227]
  v_rcp_f32 v5, v92
  v_mfma_f32_16x16x16_bf16 v[228:231], a[242:243], v[44:45], v[228:231]
  v_mul_f32 v19, v19, v5
  v_mfma_f32_16x16x32_bf16 v[240:243], a[208:211], v[40:43], v[240:243]
  v_mfma_f32_16x16x32_bf16 v[244:247], a[212:215], v[40:43], v[244:247]
L_st6:
  s_cbranch_vccnz L_stret
  v_mfma_f32_16x16x16_bf16 v[240:243], a[248:249], v[44:45], v[240:243]
  v_fma_f32 v224, v224, v5, v19
  v_fma_f32 v225, v225, v5, v19
  v_mfma_f32_16x16x16_bf16 v[244:247], a[250:251], v[44:45], v[244:247]
  v_fma_f32 v226, v226, v5, v19
  v_fma_f32 v227, v227, v5, v19
  v_mfma_f32_16x16x32_bf16 v[232:235], a[200:203], v[40:43], v[232:235]
  v_cvt_pk_bf16_f32 v224, v224, v225
  v_fma_f32 v228, v228, v5, v19
  v_mfma_f32_16x16x32_bf16 v[236:239], a[204:207], v[40:43], v[236:239]
  v_fma_f32 v229, v229, v5, v19
  v_fma_f32 v230, v230, v5, v19
  v_mfma_f32_16x16x16_bf16 v[232:235], a[244:245], v[44:45], v[232:235]
  v_fma_f32 v231, v231, v5, v19
  v_cvt_pk_bf16_f32 v225, v226, v227
  v_mfma_f32_16x16x16_bf16 v[236:239], a[246:247], v[44:45], v[236:239]
  v_cvt_pk_bf16_f32 v226, v228, v229
  v_cvt_pk_bf16_f32 v227, v230, v231
  v_mfma_f32_16x16x32_bf16 v[248:251], a[216:219], v[40:43], v[248:251]
  buffer_store_dwordx4 v[224:227], v24, s[28:31], s63 offen offset:0 sc1
  v_fma_f32 v240, v240, v5, v19
  v_fma_f32 v241, v241, v5, v19
  v_fma_f32 v242, v242, v5, v19
  v_mfma_f32_16x16x32_bf16 v[252:255], a[220:223], v[40:43], v[252:255]
  v_fma_f32 v243, v243, v5, v19
  v_fma_f32 v244, v244, v5, v19
  v_mfma_f32_16x16x16_bf16 v[248:251], a[252:253], v[44:45], v[248:251]
  v_fma_f32 v245, v245, v5, v19
  v_fma_f32 v246, v246, v5, v19
  v_mfma_f32_16x16x16_bf16 v[252:255], a[254:255], v[44:45], v[252:255]
  v_fma_f32 v247, v247, v5, v19
  v_cvt_pk_bf16_f32 v240, v240, v241
  v_cvt_pk_bf16_f32 v241, v242, v243
  v_cvt_pk_bf16_f32 v242, v244, v245
  v_cvt_pk_bf16_f32 v243, v246, v247
  buffer_store_dwordx4 v[240:243], v24, s[28:31], s63 offen offset:128 sc1
  v_pk_fma_f32 v[232:233], v[232:233], v[4:5], v[18:19] op_sel:[0,1,1] op_sel_hi:[1,1,1]
  v_pk_fma_f32 v[234:235], v[234:235], v[4:5], v[18:19] op_sel:[0,1,1] op_sel_hi:[1,1,1]
  v_pk_fma_f32 v[236:237], v[236:237], v[4:5], v[18:19] op_sel:[0,1,1] op_sel_hi:[1,1,1]
  v_pk_fma_f32 v[238:239], v[238:239], v[4:5], v[18:19] op_sel:[0,1,1] op_sel_hi:[1,1,1]
  v_cvt_pk_bf16_f32 v232, v232, v233
  v_cvt_pk_bf16_f32 v233, v234, v235
  v_cvt_pk_bf16_f32 v234, v236, v237
  v_cvt_pk_bf16_f32 v235, v238, v239
  buffer_store_dwordx4 v[232:235], v24, s[28:31], s63 offen offset:64 sc1
  v_pk_fma_f32 v[248:249], v[248:249], v[4:5], v[18:19] op_sel:[0,1,1] op_sel_hi:[1,1,1]
  v_pk_fma_f32 v[250:251], v[250:251], v[4:5], v[18:19] op_sel:[0,1,1] op_sel_hi:[1,1,1]
  v_pk_fma_f32 v[252:253], v[252:253], v[4:5], v[18:19] op_sel:[0,1,1] op_sel_hi:[1,1,1]
  v_pk_fma_f32 v[254:255], v[254:255], v[4:5], v[18:19] op_sel:[0,1,1] op_sel_hi:[1,1,1]
  v_cvt_pk_bf16_f32 v248, v248, v249
  v_cvt_pk_bf16_f32 v249, v250, v251
  v_cvt_pk_bf16_f32 v250, v252, v253
  v_cvt_pk_bf16_f32 v251, v254, v255
  buffer_store_dwordx4 v[248:251], v24, s[28:31], s63 offen offset:192 sc1
  v_add_f32 v6, v80, v84
  v_add_f32 v7, v88, v92
  v_add_f32 v7, v6, v7
  v_cmp_nge_f32 vcc, 0x53800000, v7
  s_nop 0
  s_cbranch_vccnz L_slow
L_end:
  s_endpgm
L_tail2:
  s_cmp_lg_u32 s46, 2
  s_cbranch_scc1 L_tail1
  v_mov_b32 v2, 0xff800000
  v_add_u32 v1, 0, v23
  v_cmp_le_u32 vcc, s54, v1
  s_nop 1
  v_cndmask_b32 v8, 0, v2, vcc
  v_add_u32 v1, 4, v23
  v_cmp_le_u32 vcc, s54, v1
  s_nop 1
  v_cndmask_b32 v9, 0, v2, vcc
  v_add_u32 v1, 8, v23
  v_cmp_le_u32 vcc, s54, v1
  s_nop 1
  v_cndmask_b32 v10, 0, v2, vcc
  v_add_u32 v1, 12, v23
  v_cmp_le_u32 vcc, s54, v1
  s_nop 1
  v_cndmask_b32 v11, 0, v2, vcc
  v_add_u32 v1, 2, v23
  v_cmp_le_u32 vcc, s54, v1
  s_nop 1
  v_cndmask_b32 v12, 0, v2, vcc
  v_add_u32 v1, 6, v23
  v_cmp_le_u32 vcc, s54, v1
  s_nop 1
  v_cndmask_b32 v13, 0, v2, vcc
  v_add_u32 v1, 10, v23
  v_cmp_le_u32 vcc, s54, v1
  s_nop 1
  v_cndmask_b32 v14, 0, v2, vcc
  v_add_u32 v1, 14, v23
  v_cmp_le_u32 vcc, s54, v1
  s_nop 1
  v_cndmask_b32 v15, 0, v2, vcc
  v_mfma_f32_16x16x32_bf16 v[96:99], a[64:67], a[0:3], v[48:51]
  ds_read_b64_tr_b16 a[194:195], v33 offset:512
  v_add_f32 v104, v48, v8
  v_mfma_f32_16x16x32_bf16 v[96:99], a[68:71], a[4:7], v[96:99]
  ds_read_b64_tr_b16 a[192:193], v33 offset:0
  v_add_f32 v105, v48, v9
  v_mfma_f32_16x16x32_bf16 v[96:99], a[72:75], a[8:11], v[96:99]
  ds_read_b64_tr_b16 a[226:227], v33 offset:9280
  v_add_f32 v106, v48, v10
  v_mfma_f32_16x16x32_bf16 v[96:99], a[76:79], a[12:15], v[96:99]
  ds_read_b64_tr_b16 a[224:225], v33 offset:8768
  v_add_f32 v107, v48, v11
  v_mfma_f32_16x16x32_bf16 v[100:103], a[92:95], a[12:15], v[48:51]
  ds_read_b64_tr_b16 a[230:231], v33 offset:9288
  v_add_f32 v108, v48, v12
  v_mfma_f32_16x16x32_bf16 v[100:103], a[88:91], a[8:11], v[100:103]
  ds_read_b64_tr_b16 a[228:229], v33 offset:8776
  v_add_f32 v109, v48, v13
  v_mfma_f32_16x16x32_bf16 v[100:103], a[84:87], a[4:7], v[100:103]
  ds_read_b64_tr_b16 a[198:199], v33 offset:520
  v_add_f32 v110, v48, v14
  v_mfma_f32_16x16x32_bf16 v[100:103], a[80:83], a[0:3], v[100:103]
  ds_read_b64_tr_b16 a[196:197], v33 offset:8
  v_add_f32 v111, v48, v15
  v_mfma_f32_16x16x32_bf16 v[104:107], a[96:99], a[0:3], v[104:107]
  v_exp_f32 v123, v123
  v_mfma_f32_16x16x32_bf16 v[104:107], a[100:103], a[4:7], v[104:107]
  v_exp_f32 v124, v124
  v_mfma_f32_16x16x32_bf16 v[104:107], a[104:107], a[8:11], v[104:107]
  v_exp_f32 v125, v125
  v_mfma_f32_16x16x32_bf16 v[104:107], a[108:111], a[12:15], v[104:107]
  v_exp_f32 v126, v126
  v_mfma_f32_16x16x32_bf16 v[108:111], a[112:115], a[0:3], v[108:111]
  v_exp_f32 v127, v127
  v_mfma_f32_16x16x32_bf16 v[108:111], a[116:119], a[4:7], v[108:111]
  ds_read_b64_tr_b16 a[202:203], v33 offset:576
  v_cvt_pk_bf16_f32 v77, v122, v123
  v_mfma_f32_16x16x32_bf16 v[108:111], a[120:123], a[8:11], v[108:111]
  ds_read_b64_tr_b16 a[200:201], v33 offset:64
  v_cvt_pk_bf16_f32 v78, v124, v125
  v_mfma_f32_16x16x32_bf16 v[108:111], a[124:127], a[12:15], v[108:111]
  ds_read_b64_tr_b16 a[234:235], v33 offset:9344
  v_cvt_pk_bf16_f32 v79, v126, v127
  v_mfma_f32_16x16x32_bf16 v[224:227], a[128:131], v[72:75], v[224:227]
  ds_read_b64_tr_b16 a[232:233], v33 offset:8832
  v_add_f32 v120, v52, v8
  v_mfma_f32_16x16x32_bf16 v[224:227], a[160:163], v[76:79], v[224:227]
  ds_read_b64_tr_b16 a[238:239], v33 offset:9352
  v_add_f32 v121, v52, v9
  v_mfma_f32_16x16x32_bf16 v[228:231], a[164:167], v[76:79], v[228:231]
  ds_read_b64_tr_b16 a[236:237], v33 offset:8840
  v_add_f32 v122, v52, v10
  v_mfma_f32_16x16x32_bf16 v[228:231], a[132:135], v[72:75], v[228:231]
  ds_read_b64_tr_b16 a[206:207], v33 offset:584
  v_add_f32 v123, v52, v11
  v_mfma_f32_16x16x32_bf16 v[232:235], a[136:139], v[72:75], v[232:235]
  ds_read_b64_tr_b16 a[204:205], v33 offset:72
  v_add_f32 v124, v52, v12
  v_mfma_f32_16x16x32_bf16 v[232:235], a[168:171], v[76:79], v[232:235]
  ds_read_b64_tr_b16 a[210:211], v33 offset:640
  v_add_f32 v125, v52, v13
  v_mfma_f32_16x16x32_bf16 v[236:239], a[172:175], v[76:79], v[236:239]
  ds_read_b64_tr_b16 a[208:209], v33 offset:128
  v_add_f32 v126, v52, v14
  v_mfma_f32_16x16x32_bf16 v[236:239], a[140:143], v[72:75], v[236:239]
  ds_read_b64_tr_b16 a[242:243], v33 offset:9408
  v_add_f32 v127, v52, v15
  v_mfma_f32_16x16x32_bf16 v[240:243], a[144:147], v[72:75], v[240:243]
  v_exp_f32 v96, v96
  v_mfma_f32_16x16x32_bf16 v[240:243], a[176:179], v[76:79], v[240:243]
  v_exp_f32 v97, v97
  v_mfma_f32_16x16x32_bf16 v[244:247], a[180:183], v[76:79], v[244:247]
  v_exp_f32 v98, v98
  v_mfma_f32_16x16x32_bf16 v[244:247], a[148:151], v[72:75], v[244:247]
  v_exp_f32 v99, v99
  v_mfma_f32_16x16x32_bf16 v[248:251], a[152:155], v[72:75], v[248:251]
  v_exp_f32 v100, v100
  v_mfma_f32_16x16x32_bf16 v[248:251], a[184:187], v[76:79], v[248:251]
  v_exp_f32 v101, v101
  v_mfma_f32_16x16x32_bf16 v[252:255], a[188:191], v[76:79], v[252:255]
  v_exp_f32 v102, v102
  v_mfma_f32_16x16x32_bf16 v[252:255], a[156:159], v[72:75], v[252:255]
  v_exp_f32 v103, v103
  v_smfmac_f32_16x16x64_bf16 v[92:95], v[36:39], v[72:79], v35
  v_exp_f32 v104, v104
  v_mfma_f32_16x16x32_bf16 v[112:115], a[64:67], a[16:19], v[52:55]
  v_exp_f32 v105, v105
  v_mfma_f32_16x16x32_bf16 v[112:115], a[68:71], a[20:23], v[112:115]
  v_exp_f32 v106, v106
  v_mfma_f32_16x16x32_bf16 v[112:115], a[72:75], a[24:27], v[112:115]
  v_exp_f32 v107, v107
  v_mfma_f32_16x16x32_bf16 v[112:115], a[76:79], a[28:31], v[112:115]
  v_exp_f32 v108, v108
  v_mfma_f32_16x16x32_bf16 v[116:119], a[92:95], a[28:31], v[52:55]
  v_exp_f32 v109, v109
  v_mfma_f32_16x16x32_bf16 v[116:119], a[88:91], a[24:27], v[116:119]
  v_exp_f32 v110, v110
  v_mfma_f32_16x16x32_bf16 v[116:119], a[84:87], a[20:23], v[116:119]
  v_exp_f32 v111, v111
  v_mfma_f32_16x16x32_bf16 v[116:119], a[80:83], a[16:19], v[116:119]
  ds_read_b64_tr_b16 a[240:241], v33 offset:8896
  v_cvt_pk_bf16_f32 v64, v96, v97
  v_mfma_f32_16x16x32_bf16 v[120:123], a[96:99], a[16:19], v[120:123]
  ds_read_b64_tr_b16 a[246:247], v33 offset:9416
  v_cvt_pk_bf16_f32 v65, v98, v99
  v_mfma_f32_16x16x32_bf16 v[120:123], a[100:103], a[20:23], v[120:123]
  ds_read_b64_tr_b16 a[244:245], v33 offset:8904
  v_cvt_pk_bf16_f32 v66, v100, v101
  v_mfma_f32_16x16x32_bf16 v[120:123], a[104:107], a[24:27], v[120:123]
  ds_read_b64_tr_b16 a[214:215], v33 offset:648
  v_cvt_pk_bf16_f32 v67, v102, v103
  v_mfma_f32_16x16x32_bf16 v[120:123], a[108:111], a[28:31], v[120:123]
  ds_read_b64_tr_b16 a[212:213], v33 offset:136
  v_cvt_pk_bf16_f32 v68, v104, v105
  v_mfma_f32_16x16x32_bf16 v[124:127], a[112:115], a[16:19], v[124:127]
  ds_read_b64_tr_b16 a[218:219], v33 offset:704
  v_cvt_pk_bf16_f32 v69, v106, v107
  v_mfma_f32_16x16x32_bf16 v[124:127], a[116:119], a[20:23], v[124:127]
  ds_read_b64_tr_b16 a[216:217], v33 offset:192
  v_cvt_pk_bf16_f32 v70, v108, v109
  v_mfma_f32_16x16x32_bf16 v[124:127], a[120:123], a[24:27], v[124:127]
  ds_read_b64_tr_b16 a[250:251], v33 offset:9472
  v_cvt_pk_bf16_f32 v71, v110, v111
  v_mfma_f32_16x16x32_bf16 v[124:127], a[124:127], a[28:31], v[124:127]
  ds_read_b64_tr_b16 a[248:249], v33 offset:8960
  v_add_f32 v104, v56, v8
  v_smfmac_f32_16x16x64_bf16 v[80:83], v[36:39], v[64:71], v35
  s_waitcnt lgkmcnt(5)
  ds_read_b64_tr_b16 a[254:255], v33 offset:9480
  v_add_f32 v105, v56, v9
  v_mfma_f32_16x16x32_bf16 v[128:131], a[192:195], v[64:67], v[128:131]
  ds_read_b64_tr_b16 a[252:253], v33 offset:8968
  v_add_f32 v106, v56, v10
  v_mfma_f32_16x16x32_bf16 v[128:131], a[224:227], v[68:71], v[128:131]
  ds_read_b64_tr_b16 a[222:223], v33 offset:712
  v_add_f32 v107, v56, v11
  v_mfma_f32_16x16x32_bf16 v[132:135], a[228:231], v[68:71], v[132:135]
  ds_read_b64_tr_b16 a[220:221], v33 offset:200
  v_add_f32 v80, v80, v81
  v_mfma_f32_16x16x32_bf16 v[132:135], a[196:199], v[64:67], v[132:135]
  v_add_f32 v82, v82, v83
  v_add_f32 v80, v80, v82
  v_mfma_f32_16x16x32_bf16 v[136:139], a[200:203], v[64:67], v[136:139]
  v_rcp_f32 v2, v80
  v_mfma_f32_16x16x32_bf16 v[136:139], a[232:235], v[68:71], v[136:139]
  v_mul_f32 v16, v16, v2
  v_fma_f32 v128, v128, v2, v16
  v_mfma_f32_16x16x32_bf16 v[140:143], a[236:239], v[68:71], v[140:143]
  v_fma_f32 v129, v129, v2, v16
  v_fma_f32 v130, v130, v2, v16
  v_mfma_f32_16x16x32_bf16 v[140:143], a[204:207], v[64:67], v[140:143]
  v_fma_f32 v131, v131, v2, v16
  v_cvt_pk_bf16_f32 v128, v128, v129
  v_mfma_f32_16x16x32_bf16 v[144:147], a[208:211], v[64:67], v[144:147]
  v_fma_f32 v132, v132, v2, v16
  v_fma_f32 v133, v133, v2, v16
  v_mfma_f32_16x16x32_bf16 v[144:147], a[240:243], v[68:71], v[144:147]
  v_fma_f32 v134, v134, v2, v16
  v_fma_f32 v135, v135, v2, v16
  v_mfma_f32_16x16x32_bf16 v[148:151], a[244:247], v[68:71], v[148:151]
  s_waitcnt lgkmcnt(0)
  v_cvt_pk_bf16_f32 v129, v130, v131
  v_cvt_pk_bf16_f32 v130, v132, v133
  v_mfma_f32_16x16x32_bf16 v[148:151], a[212:215], v[64:67], v[148:151]
  v_cvt_pk_bf16_f32 v131, v134, v135
  v_add_f32 v108, v56, v12
  v_mfma_f32_16x16x32_bf16 v[152:155], a[216:219], v[64:67], v[152:155]
  buffer_store_dwordx4 v[128:131], v24, s[28:31], s60 offen offset:0 sc1
  v_add_f32 v109, v56, v13
  v_add_f32 v110, v56, v14
  v_add_f32 v111, v56, v15
  v_mfma_f32_16x16x32_bf16 v[152:155], a[248:251], v[68:71], v[152:155]
  v_fma_f32 v136, v136, v2, v16
  v_fma_f32 v137, v137, v2, v16
  v_mfma_f32_16x16x32_bf16 v[156:159], a[252:255], v[68:71], v[156:159]
  v_fma_f32 v138, v138, v2, v16
  v_fma_f32 v139, v139, v2, v16
  v_mfma_f32_16x16x32_bf16 v[156:159], a[220:223], v[64:67], v[156:159]
  v_cvt_pk_bf16_f32 v136, v136, v137
  v_fma_f32 v140, v140, v2, v16
  v_mfma_f32_16x16x32_bf16 v[96:99], a[64:67], a[32:35], v[56:59]
  v_exp_f32 v112, v112
  v_mfma_f32_16x16x32_bf16 v[96:99], a[68:71], a[36:39], v[96:99]
  v_exp_f32 v113, v113
  v_mfma_f32_16x16x32_bf16 v[96:99], a[72:75], a[40:43], v[96:99]
  v_exp_f32 v114, v114
  v_mfma_f32_16x16x32_bf16 v[96:99], a[76:79], a[44:47], v[96:99]
  v_exp_f32 v115, v115
  v_mfma_f32_16x16x32_bf16 v[100:103], a[92:95], a[44:47], v[56:59]
  v_exp_f32 v116, v116
  v_mfma_f32_16x16x32_bf16 v[100:103], a[88:91], a[40:43], v[100:103]
  v_exp_f32 v117, v117
  v_mfma_f32_16x16x32_bf16 v[100:103], a[84:87], a[36:39], v[100:103]
  v_exp_f32 v118, v118
  v_mfma_f32_16x16x32_bf16 v[100:103], a[80:83], a[32:35], v[100:103]
  v_exp_f32 v119, v119
  v_mfma_f32_16x16x32_bf16 v[104:107], a[96:99], a[32:35], v[104:107]
  v_exp_f32 v120, v120
  v_mfma_f32_16x16x32_bf16 v[104:107], a[100:103], a[36:39], v[104:107]
  v_exp_f32 v121, v121
  v_mfma_f32_16x16x32_bf16 v[104:107], a[104:107], a[40:43], v[104:107]
  v_exp_f32 v122, v122
  v_mfma_f32_16x16x32_bf16 v[104:107], a[108:111], a[44:47], v[104:107]
  v_exp_f32 v123, v123
  v_mfma_f32_16x16x32_bf16 v[108:111], a[112:115], a[32:35], v[108:111]
  v_exp_f32 v124, v124
  v_mfma_f32_16x16x32_bf16 v[108:111], a[116:119], a[36:39], v[108:111]
  v_exp_f32 v125, v125
  v_mfma_f32_16x16x32_bf16 v[108:111], a[120:123], a[40:43], v[108:111]
  v_exp_f32 v126, v126
  v_mfma_f32_16x16x32_bf16 v[108:111], a[124:127], a[44:47], v[108:111]
  v_exp_f32 v127, v127
  v_fma_f32 v141, v141, v2, v16
  v_fma_f32 v142, v142, v2, v16
  v_fma_f32 v143, v143, v2, v16
  v_cvt_pk_bf16_f32 v137, v138, v139
  v_cvt_pk_bf16_f32 v138, v140, v141
  v_cvt_pk_bf16_f32 v139, v142, v143
  v_cvt_pk_bf16_f32 v72, v112, v113
  v_cvt_pk_bf16_f32 v73, v114, v115
  v_cvt_pk_bf16_f32 v74, v116, v117
  v_cvt_pk_bf16_f32 v75, v118, v119
  v_cvt_pk_bf16_f32 v76, v120, v121
  v_cvt_pk_bf16_f32 v77, v122, v123
  v_cvt_pk_bf16_f32 v78, v124, v125
  v_cvt_pk_bf16_f32 v79, v126, v127
  s_nop 1
  v_smfmac_f32_16x16x64_bf16 v[84:87], v[36:39], v[72:79], v35
  buffer_store_dwordx4 v[136:139], v24, s[28:31], s60 offen offset:64 sc1
  v_fma_f32 v144, v144, v2, v16
  v_fma_f32 v145, v145, v2, v16
  v_fma_f32 v146, v146, v2, v16
  v_mfma_f32_16x16x32_bf16 v[160:163], a[192:195], v[72:75], v[160:163]
  v_fma_f32 v147, v147, v2, v16
  v_cvt_pk_bf16_f32 v144, v144, v145
  v_mfma_f32_16x16x32_bf16 v[160:163], a[224:227], v[76:79], v[160:163]
  v_fma_f32 v148, v148, v2, v16
  v_fma_f32 v149, v149, v2, v16
  v_mfma_f32_16x16x32_bf16 v[164:167], a[228:231], v[76:79], v[164:167]
  v_fma_f32 v150, v150, v2, v16
  v_fma_f32 v151, v151, v2, v16
  v_mfma_f32_16x16x32_bf16 v[164:167], a[196:199], v[72:75], v[164:167]
  v_cvt_pk_bf16_f32 v145, v146, v147
  v_cvt_pk_bf16_f32 v146, v148, v149
  v_mfma_f32_16x16x32_bf16 v[168:171], a[200:203], v[72:75], v[168:171]
  v_cvt_pk_bf16_f32 v147, v150, v151
  v_fma_f32 v152, v152, v2, v16
  v_mfma_f32_16x16x32_bf16 v[168:171], a[232:235], v[76:79], v[168:171]
  buffer_store_dwordx4 v[144:147], v24, s[28:31], s60 offen offset:128 sc1
  v_fma_f32 v153, v153, v2, v16
  v_fma_f32 v154, v154, v2, v16
  v_fma_f32 v155, v155, v2, v16
  v_mfma_f32_16x16x32_bf16 v[172:175], a[236:239], v[76:79], v[172:175]
  v_cvt_pk_bf16_f32 v152, v152, v153
  v_fma_f32 v156, v156, v2, v16
  v_mfma_f32_16x16x32_bf16 v[172:175], a[204:207], v[72:75], v[172:175]
  v_fma_f32 v157, v157, v2, v16
  v_fma_f32 v158, v158, v2, v16
  v_mfma_f32_16x16x32_bf16 v[176:179], a[208:211], v[72:75], v[176:179]
  v_fma_f32 v159, v159, v2, v16
  v_cvt_pk_bf16_f32 v153, v154, v155
  v_mfma_f32_16x16x32_bf16 v[176:179], a[240:243], v[76:79], v[176:179]
  v_cvt_pk_bf16_f32 v154, v156, v157
  v_cvt_pk_bf16_f32 v155, v158, v159
  v_mfma_f32_16x16x32_bf16 v[180:183], a[244:247], v[76:79], v[180:183]
  buffer_store_dwordx4 v[152:155], v24, s[28:31], s60 offen offset:192 sc1
  v_add_f32 v84, v84, v85
  v_add_f32 v86, v86, v87
  v_add_f32 v84, v84, v86
  v_mfma_f32_16x16x32_bf16 v[180:183], a[212:215], v[72:75], v[180:183]
  v_rcp_f32 v3, v84
  v_mfma_f32_16x16x32_bf16 v[184:187], a[216:219], v[72:75], v[184:187]
  v_mul_f32 v17, v17, v3
  v_fma_f32 v160, v160, v3, v17
  v_mfma_f32_16x16x32_bf16 v[184:187], a[248:251], v[76:79], v[184:187]
  v_fma_f32 v161, v161, v3, v17
  v_fma_f32 v162, v162, v3, v17
  v_mfma_f32_16x16x32_bf16 v[188:191], a[252:255], v[76:79], v[188:191]
  v_fma_f32 v163, v163, v3, v17
  v_cvt_pk_bf16_f32 v160, v160, v161
  v_mfma_f32_16x16x32_bf16 v[188:191], a[220:223], v[72:75], v[188:191]
  v_fma_f32 v164, v164, v3, v17
  v_fma_f32 v165, v165, v3, v17
  v_mfma_f32_16x16x32_bf16 v[112:115], a[64:67], a[48:51], v[60:63]
  v_fma_f32 v166, v166, v3, v17
  v_fma_f32 v167, v167, v3, v17
  v_mfma_f32_16x16x32_bf16 v[112:115], a[68:71], a[52:55], v[112:115]
  v_cvt_pk_bf16_f32 v161, v162, v163
  v_cvt_pk_bf16_f32 v162, v164, v165
  v_mfma_f32_16x16x32_bf16 v[112:115], a[72:75], a[56:59], v[112:115]
  v_cvt_pk_bf16_f32 v163, v166, v167
  v_add_f32 v120, v60, v8
  v_mfma_f32_16x16x32_bf16 v[112:115], a[76:79], a[60:63], v[112:115]
  buffer_store_dwordx4 v[160:163], v24, s[28:31], s61 offen offset:0 sc1
  v_add_f32 v121, v60, v9
  v_add_f32 v122, v60, v10
  v_add_f32 v123, v60, v11
  v_mfma_f32_16x16x32_bf16 v[116:119], a[92:95], a[60:63], v[60:63]
  v_add_f32 v124, v60, v12
  v_add_f32 v125, v60, v13
  v_mfma_f32_16x16x32_bf16 v[116:119], a[88:91], a[56:59], v[116:119]
  v_add_f32 v126, v60, v14
  v_add_f32 v127, v60, v15
  v_mfma_f32_16x16x32_bf16 v[116:119], a[84:87], a[52:55], v[116:119]
  v_fma_f32 v168, v168, v3, v17
  v_fma_f32 v169, v169, v3, v17
  v_mfma_f32_16x16x32_bf16 v[116:119], a[80:83], a[48:51], v[116:119]
  v_fma_f32 v170, v170, v3, v17
  v_fma_f32 v171, v171, v3, v17
  v_mfma_f32_16x16x32_bf16 v[120:123], a[96:99], a[48:51], v[120:123]
  v_cvt_pk_bf16_f32 v168, v168, v169
  v_fma_f32 v172, v172, v3, v17
  v_mfma_f32_16x16x32_bf16 v[120:123], a[100:103], a[52:55], v[120:123]
  v_exp_f32 v96, v96
  v_mfma_f32_16x16x32_bf16 v[120:123], a[104:107], a[56:59], v[120:123]
  v_exp_f32 v97, v97
  v_mfma_f32_16x16x32_bf16 v[120:123], a[108:111], a[60:63], v[120:123]
  v_exp_f32 v98, v98
  v_mfma_f32_16x16x32_bf16 v[124:127], a[112:115], a[48:51], v[124:127]
  v_exp_f32 v99, v99
  v_mfma_f32_16x16x32_bf16 v[124:127], a[116:119], a[52:55], v[124:127]
  v_exp_f32 v100, v100
  v_mfma_f32_16x16x32_bf16 v[124:127], a[120:123], a[56:59], v[124:127]
  v_exp_f32 v101, v101
  v_mfma_f32_16x16x32_bf16 v[124:127], a[124:127], a[60:63], v[124:127]
  v_exp_f32 v102, v102
  v_exp_f32 v103, v103
  v_exp_f32 v104, v104
  v_exp_f32 v105, v105
  v_exp_f32 v106, v106
  v_exp_f32 v107, v107
  v_exp_f32 v108, v108
  v_exp_f32 v109, v109
  v_exp_f32 v110, v110
  v_exp_f32 v111, v111
  v_fma_f32 v173, v173, v3, v17
  v_fma_f32 v174, v174, v3, v17
  v_fma_f32 v175, v175, v3, v17
  v_cvt_pk_bf16_f32 v169, v170, v171
  v_cvt_pk_bf16_f32 v170, v172, v173
  v_cvt_pk_bf16_f32 v171, v174, v175
  v_cvt_pk_bf16_f32 v64, v96, v97
  v_cvt_pk_bf16_f32 v65, v98, v99
  v_cvt_pk_bf16_f32 v66, v100, v101
  v_cvt_pk_bf16_f32 v67, v102, v103
  v_cvt_pk_bf16_f32 v68, v104, v105
  v_cvt_pk_bf16_f32 v69, v106, v107
  v_cvt_pk_bf16_f32 v70, v108, v109
  v_cvt_pk_bf16_f32 v71, v110, v111
  s_nop 1
  v_smfmac_f32_16x16x64_bf16 v[88:91], v[36:39], v[64:71], v35
  buffer_store_dwordx4 v[168:171], v24, s[28:31], s61 offen offset:64 sc1
  v_fma_f32 v176, v176, v3, v17
  v_fma_f32 v177, v177, v3, v17
  v_fma_f32 v178, v178, v3, v17
  v_mfma_f32_16x16x32_bf16 v[192:195], a[192:195], v[64:67], v[192:195]
  v_fma_f32 v179, v179, v3, v17
  v_cvt_pk_bf16_f32 v176, v176, v177
  v_mfma_f32_16x16x32_bf16 v[192:195], a[224:227], v[68:71], v[192:195]
  v_fma_f32 v180, v180, v3, v17
  v_fma_f32 v181, v181, v3, v17
  v_mfma_f32_16x16x32_bf16 v[196:199], a[228:231], v[68:71], v[196:199]
  v_fma_f32 v182, v182, v3, v17
  v_fma_f32 v183, v183, v3, v17
  v_mfma_f32_16x16x32_bf16 v[196:199], a[196:199], v[64:67], v[196:199]
  v_cvt_pk_bf16_f32 v177, v178, v179
  v_cvt_pk_bf16_f32 v178, v180, v181
  v_mfma_f32_16x16x32_bf16 v[200:203], a[200:203], v[64:67], v[200:203]
  v_cvt_pk_bf16_f32 v179, v182, v183
  v_fma_f32 v184, v184, v3, v17
  v_mfma_f32_16x16x32_bf16 v[200:203], a[232:235], v[68:71], v[200:203]
  buffer_store_dwordx4 v[176:179], v24, s[28:31], s61 offen offset:128 sc1
  v_fma_f32 v185, v185, v3, v17
  v_fma_f32 v186, v186, v3, v17
  v_fma_f32 v187, v187, v3, v17
  v_mfma_f32_16x16x32_bf16 v[204:207], a[236:239], v[68:71], v[204:207]
  v_cvt_pk_bf16_f32 v184, v184, v185
  v_fma_f32 v188, v188, v3, v17
  v_mfma_f32_16x16x32_bf16 v[204:207], a[204:207], v[64:67], v[204:207]
  v_fma_f32 v189, v189, v3, v17
  v_fma_f32 v190, v190, v3, v17
  v_mfma_f32_16x16x32_bf16 v[208:211], a[208:211], v[64:67], v[208:211]
  v_fma_f32 v191, v191, v3, v17
  v_cvt_pk_bf16_f32 v185, v186, v187
  v_mfma_f32_16x16x32_bf16 v[208:211], a[240:243], v[68:71], v[208:211]
  v_cvt_pk_bf16_f32 v186, v188, v189
  v_cvt_pk_bf16_f32 v187, v190, v191
  v_mfma_f32_16x16x32_bf16 v[212:215], a[244:247], v[68:71], v[212:215]
  buffer_store_dwordx4 v[184:187], v24, s[28:31], s61 offen offset:192 sc1
  v_exp_f32 v112, v112
  v_add_f32 v88, v88, v89
  v_mfma_f32_16x16x32_bf16 v[212:215], a[212:215], v[64:67], v[212:215]
  v_exp_f32 v113, v113
  v_mfma_f32_16x16x32_bf16 v[216:219], a[216:219], v[64:67], v[216:219]
  v_exp_f32 v114, v114
  v_mfma_f32_16x16x32_bf16 v[216:219], a[248:251], v[68:71], v[216:219]
  v_exp_f32 v115, v115
  v_mfma_f32_16x16x32_bf16 v[220:223], a[252:255], v[68:71], v[220:223]
  v_exp_f32 v116, v116
  v_mfma_f32_16x16x32_bf16 v[220:223], a[220:223], v[64:67], v[220:223]
  v_exp_f32 v117, v117
  v_exp_f32 v118, v118
  v_exp_f32 v119, v119
  v_exp_f32 v120, v120
  v_exp_f32 v121, v121
  v_exp_f32 v122, v122
  v_exp_f32 v123, v123
  v_exp_f32 v124, v124
  v_exp_f32 v125, v125
  v_exp_f32 v126, v126
  v_exp_f32 v127, v127
  v_cvt_pk_bf16_f32 v72, v112, v113
  v_cvt_pk_bf16_f32 v73, v114, v115
  v_cvt_pk_bf16_f32 v74, v116, v117
  v_cvt_pk_bf16_f32 v75, v118, v119
  v_cvt_pk_bf16_f32 v76, v120, v121
  v_cvt_pk_bf16_f32 v77, v122, v123
  v_cvt_pk_bf16_f32 v78, v124, v125
  v_cvt_pk_bf16_f32 v79, v126, v127
  v_add_f32 v90, v90, v91
  v_add_f32 v88, v88, v90
  v_smfmac_f32_16x16x64_bf16 v[92:95], v[36:39], v[72:79], v35
  v_rcp_f32 v4, v88
  v_mfma_f32_16x16x32_bf16 v[224:227], a[192:195], v[72:75], v[224:227]
  v_mul_f32 v18, v18, v4
  v_fma_f32 v192, v192, v4, v18
  v_mfma_f32_16x16x32_bf16 v[224:227], a[224:227], v[76:79], v[224:227]
  v_fma_f32 v193, v193, v4, v18
  v_fma_f32 v194, v194, v4, v18
  v_mfma_f32_16x16x32_bf16 v[228:231], a[228:231], v[76:79], v[228:231]
  v_fma_f32 v195, v195, v4, v18
  v_fma_f32 v196, v196, v4, v18
  v_mfma_f32_16x16x32_bf16 v[228:231], a[196:199], v[72:75], v[228:231]
  v_fma_f32 v197, v197, v4, v18
  v_fma_f32 v198, v198, v4, v18
  v_mfma_f32_16x16x32_bf16 v[232:235], a[200:203], v[72:75], v[232:235]
  v_fma_f32 v199, v199, v4, v18
  v_cvt_pk_bf16_f32 v192, v192, v193
  v_mfma_f32_16x16x32_bf16 v[232:235], a[232:235], v[76:79], v[232:235]
  v_cvt_pk_bf16_f32 v193, v194, v195
  v_cvt_pk_bf16_f32 v194, v196, v197
  v_mfma_f32_16x16x32_bf16 v[236:239], a[236:239], v[76:79], v[236:239]
  v_cvt_pk_bf16_f32 v195, v198, v199
  v_fma_f32 v200, v200, v4, v18
  v_mfma_f32_16x16x32_bf16 v[236:239], a[204:207], v[72:75], v[236:239]
  buffer_store_dwordx4 v[192:195], v24, s[28:31], s62 offen offset:0 sc1
  v_fma_f32 v201, v201, v4, v18
  v_fma_f32 v202, v202, v4, v18
  v_fma_f32 v203, v203, v4, v18
  v_mfma_f32_16x16x32_bf16 v[240:243], a[208:211], v[72:75], v[240:243]
  v_fma_f32 v204, v204, v4, v18
  v_fma_f32 v205, v205, v4, v18
  v_mfma_f32_16x16x32_bf16 v[240:243], a[240:243], v[76:79], v[240:243]
  v_fma_f32 v206, v206, v4, v18
  v_fma_f32 v207, v207, v4, v18
  v_mfma_f32_16x16x32_bf16 v[244:247], a[244:247], v[76:79], v[244:247]
  v_cvt_pk_bf16_f32 v200, v200, v201
  v_cvt_pk_bf16_f32 v201, v202, v203
  v_mfma_f32_16x16x32_bf16 v[244:247], a[212:215], v[72:75], v[244:247]
  v_cvt_pk_bf16_f32 v202, v204, v205
  v_cvt_pk_bf16_f32 v203, v206, v207
  v_mfma_f32_16x16x32_bf16 v[248:251], a[216:219], v[72:75], v[248:251]
  buffer_store_dwordx4 v[200:203], v24, s[28:31], s62 offen offset:64 sc1
  v_fma_f32 v208, v208, v4, v18
  v_fma_f32 v209, v209, v4, v18
  v_fma_f32 v210, v210, v4, v18
  v_mfma_f32_16x16x32_bf16 v[248:251], a[248:251], v[76:79], v[248:251]
  v_fma_f32 v211, v211, v4, v18
  v_fma_f32 v212, v212, v4, v18
  v_mfma_f32_16x16x32_bf16 v[252:255], a[252:255], v[76:79], v[252:255]
  v_fma_f32 v213, v213, v4, v18
  v_fma_f32 v214, v214, v4, v18
  v_mfma_f32_16x16x32_bf16 v[252:255], a[220:223], v[72:75], v[252:255]
  v_fma_f32 v215, v215, v4, v18
  v_cvt_pk_bf16_f32 v208, v208, v209
  v_cvt_pk_bf16_f32 v209, v210, v211
  v_cvt_pk_bf16_f32 v210, v212, v213
  v_cvt_pk_bf16_f32 v211, v214, v215
  buffer_store_dwordx4 v[208:211], v24, s[28:31], s62 offen offset:128 sc1
  v_fma_f32 v216, v216, v4, v18
  v_fma_f32 v217, v217, v4, v18
  v_fma_f32 v218, v218, v4, v18
  v_fma_f32 v219, v219, v4, v18
  v_fma_f32 v220, v220, v4, v18
  v_fma_f32 v221, v221, v4, v18
  v_fma_f32 v222, v222, v4, v18
  v_fma_f32 v223, v223, v4, v18
  v_cvt_pk_bf16_f32 v216, v216, v217
  v_cvt_pk_bf16_f32 v217, v218, v219
  v_cvt_pk_bf16_f32 v218, v220, v221
  v_cvt_pk_bf16_f32 v219, v222, v223
  buffer_store_dwordx4 v[216:219], v24, s[28:31], s62 offen offset:192 sc1
  v_add_f32 v92, v92, v93
  v_add_f32 v94, v94, v95
  v_add_f32 v92, v92, v94
  v_rcp_f32 v5, v92
  s_nop 0
  v_mul_f32 v19, v19, v5
  v_fma_f32 v224, v224, v5, v19
  v_fma_f32 v225, v225, v5, v19
  v_fma_f32 v226, v226, v5, v19
  v_fma_f32 v227, v227, v5, v19
  v_fma_f32 v228, v228, v5, v19
  v_fma_f32 v229, v229, v5, v19
  v_fma_f32 v230, v230, v5, v19
  v_fma_f32 v231, v231, v5, v19
  v_cvt_pk_bf16_f32 v224, v224, v225
  v_cvt_pk_bf16_f32 v225, v226, v227
  v_cvt_pk_bf16_f32 v226, v228, v229
  v_cvt_pk_bf16_f32 v227, v230, v231
  buffer_store_dwordx4 v[224:227], v24, s[28:31], s63 offen offset:0 sc1
  v_fma_f32 v232, v232, v5, v19
  v_fma_f32 v233, v233, v5, v19
  v_fma_f32 v234, v234, v5, v19
  v_fma_f32 v235, v235, v5, v19
  v_fma_f32 v236, v236, v5, v19
  v_fma_f32 v237, v237, v5, v19
  v_fma_f32 v238, v238, v5, v19
  v_fma_f32 v239, v239, v5, v19
  v_cvt_pk_bf16_f32 v232, v232, v233
  v_cvt_pk_bf16_f32 v233, v234, v235
  v_cvt_pk_bf16_f32 v234, v236, v237
  v_cvt_pk_bf16_f32 v235, v238, v239
  buffer_store_dwordx4 v[232:235], v24, s[28:31], s63 offen offset:64 sc1
  v_fma_f32 v240, v240, v5, v19
  v_fma_f32 v241, v241, v5, v19
  v_fma_f32 v242, v242, v5, v19
  v_fma_f32 v243, v243, v5, v19
  v_fma_f32 v244, v244, v5, v19
  v_fma_f32 v245, v245, v5, v19
  v_fma_f32 v246, v246, v5, v19
  v_fma_f32 v247, v247, v5, v19
  v_cvt_pk_bf16_f32 v240, v240, v241
  v_cvt_pk_bf16_f32 v241, v242, v243
  v_cvt_pk_bf16_f32 v242, v244, v245
  v_cvt_pk_bf16_f32 v243, v246, v247
  buffer_store_dwordx4 v[240:243], v24, s[28:31], s63 offen offset:128 sc1
  v_fma_f32 v248, v248, v5, v19
  v_fma_f32 v249, v249, v5, v19
  v_fma_f32 v250, v250, v5, v19
  v_fma_f32 v251, v251, v5, v19
  v_fma_f32 v252, v252, v5, v19
  v_fma_f32 v253, v253, v5, v19
  v_fma_f32 v254, v254, v5, v19
  v_fma_f32 v255, v255, v5, v19
  v_cvt_pk_bf16_f32 v248, v248, v249
  v_cvt_pk_bf16_f32 v249, v250, v251
  v_cvt_pk_bf16_f32 v250, v252, v253
  v_cvt_pk_bf16_f32 v251, v254, v255
  buffer_store_dwordx4 v[248:251], v24, s[28:31], s63 offen offset:192 sc1
  v_add_f32 v6, v80, v84
  v_add_f32 v7, v88, v92
  v_add_f32 v7, v6, v7
  v_cmp_nge_f32 vcc, 0x53800000, v7
  s_nop 0
  s_cbranch_vccnz L_slow
  s_endpgm
L_tail1:
  v_mov_b32 v2, 0xff800000
  v_add_u32 v1, 0, v23
  v_cmp_le_u32 vcc, s54, v1
  s_nop 1
  v_cndmask_b32 v8, 0, v2, vcc
  v_add_u32 v1, 4, v23
  v_cmp_le_u32 vcc, s54, v1
  s_nop 1
  v_cndmask_b32 v9, 0, v2, vcc
  v_add_u32 v1, 8, v23
  v_cmp_le_u32 vcc, s54, v1
  s_nop 1
  v_cndmask_b32 v10, 0, v2, vcc
  v_add_u32 v1, 12, v23
  v_cmp_le_u32 vcc, s54, v1
  s_nop 1
  v_cndmask_b32 v11, 0, v2, vcc
  v_add_u32 v1, 2, v23
  v_cmp_le_u32 vcc, s54, v1
  s_nop 1
  v_cndmask_b32 v12, 0, v2, vcc
  v_add_u32 v1, 6, v23
  v_cmp_le_u32 vcc, s54, v1
  s_nop 1
  v_cndmask_b32 v13, 0, v2, vcc
  v_add_u32 v1, 10, v23
  v_cmp_le_u32 vcc, s54, v1
  s_nop 1
  v_cndmask_b32 v14, 0, v2, vcc
  v_add_u32 v1, 14, v23
  v_cmp_le_u32 vcc, s54, v1
  s_nop 1
  v_cndmask_b32 v15, 0, v2, vcc
  v_add_f32 v96, v48, v8
  v_add_f32 v97, v48, v9
  v_add_f32 v98, v48, v10
  v_add_f32 v99, v48, v11
  v_add_f32 v100, v48, v12
  v_add_f32 v101, v48, v13
  v_mfma_f32_16x16x32_bf16 v[96:99], a[64:67], a[0:3], v[96:99]
  ds_read_b64_tr_b16 a[194:195], v33 offset:512
  v_add_f32 v102, v48, v14
  v_mfma_f32_16x16x32_bf16 v[96:99], a[68:71], a[4:7], v[96:99]
  ds_read_b64_tr_b16 a[192:193], v33 offset:0
  v_add_f32 v103, v48, v15
  v_mfma_f32_16x16x32_bf16 v[96:99], a[72:75], a[8:11], v[96:99]
  v_exp_f32 v123, v123
  v_mfma_f32_16x16x32_bf16 v[96:99], a[76:79], a[12:15], v[96:99]
  v_exp_f32 v124, v124
  v_mfma_f32_16x16x32_bf16 v[100:103], a[80:83], a[0:3], v[100:103]
  v_exp_f32 v125, v125
  v_mfma_f32_16x16x32_bf16 v[100:103], a[84:87], a[4:7], v[100:103]
  v_exp_f32 v126, v126
  v_mfma_f32_16x16x32_bf16 v[100:103], a[88:91], a[8:11], v[100:103]
  v_exp_f32 v127, v127
  v_mfma_f32_16x16x32_bf16 v[100:103], a[92:95], a[12:15], v[100:103]
  ds_read_b64_tr_b16 a[198:199], v33 offset:520
  v_cvt_pk_bf16_f32 v77, v122, v123
  v_mfma_f32_16x16x32_bf16 v[224:227], a[128:131], v[72:75], v[224:227]
  v_cvt_pk_bf16_f32 v78, v124, v125
  v_cvt_pk_bf16_f32 v79, v126, v127
  v_add_f32 v112, v52, v8
  v_add_f32 v113, v52, v9
  v_mfma_f32_16x16x32_bf16 v[224:227], a[160:163], v[76:79], v[224:227]
  ds_read_b64_tr_b16 a[196:197], v33 offset:8
  v_add_f32 v114, v52, v10
  v_mfma_f32_16x16x32_bf16 v[228:231], a[164:167], v[76:79], v[228:231]
  ds_read_b64_tr_b16 a[202:203], v33 offset:576
  v_add_f32 v115, v52, v11
  v_mfma_f32_16x16x32_bf16 v[228:231], a[132:135], v[72:75], v[228:231]
  ds_read_b64_tr_b16 a[200:201], v33 offset:64
  v_add_f32 v116, v52, v12
  v_mfma_f32_16x16x32_bf16 v[232:235], a[136:139], v[72:75], v[232:235]
  ds_read_b64_tr_b16 a[206:207], v33 offset:584
  v_add_f32 v117, v52, v13
  v_mfma_f32_16x16x32_bf16 v[232:235], a[168:171], v[76:79], v[232:235]
  ds_read_b64_tr_b16 a[204:205], v33 offset:72
  v_add_f32 v118, v52, v14
  v_mfma_f32_16x16x32_bf16 v[236:239], a[172:175], v[76:79], v[236:239]
  ds_read_b64_tr_b16 a[210:211], v33 offset:640
  v_add_f32 v119, v52, v15
  v_mfma_f32_16x16x32_bf16 v[236:239], a[140:143], v[72:75], v[236:239]
  ds_read_b64_tr_b16 a[208:209], v33 offset:128
  v_mov_b64 v[68:69], 0
  v_mfma_f32_16x16x32_bf16 v[240:243], a[144:147], v[72:75], v[240:243]
  ds_read_b64_tr_b16 a[214:215], v33 offset:648
  v_mov_b64 v[70:71], 0
  v_mfma_f32_16x16x32_bf16 v[240:243], a[176:179], v[76:79], v[240:243]
  v_exp_f32 v96, v96
  v_mfma_f32_16x16x32_bf16 v[244:247], a[180:183], v[76:79], v[244:247]
  v_exp_f32 v97, v97
  v_mfma_f32_16x16x32_bf16 v[244:247], a[148:151], v[72:75], v[244:247]
  v_exp_f32 v98, v98
  v_mfma_f32_16x16x32_bf16 v[248:251], a[152:155], v[72:75], v[248:251]
  v_exp_f32 v99, v99
  v_mfma_f32_16x16x32_bf16 v[248:251], a[184:187], v[76:79], v[248:251]
  v_exp_f32 v100, v100
  v_mfma_f32_16x16x32_bf16 v[252:255], a[188:191], v[76:79], v[252:255]
  v_exp_f32 v101, v101
  v_mfma_f32_16x16x32_bf16 v[252:255], a[156:159], v[72:75], v[252:255]
  v_exp_f32 v102, v102
  v_smfmac_f32_16x16x64_bf16 v[92:95], v[36:39], v[72:79], v35
  v_exp_f32 v103, v103
  v_mfma_f32_16x16x32_bf16 v[112:115], a[64:67], a[16:19], v[112:115]
  ds_read_b64_tr_b16 a[212:213], v33 offset:136
  v_cvt_pk_bf16_f32 v64, v96, v97
  v_mfma_f32_16x16x32_bf16 v[112:115], a[68:71], a[20:23], v[112:115]
  ds_read_b64_tr_b16 a[218:219], v33 offset:704
  v_cvt_pk_bf16_f32 v65, v98, v99
  v_mfma_f32_16x16x32_bf16 v[112:115], a[72:75], a[24:27], v[112:115]
  ds_read_b64_tr_b16 a[216:217], v33 offset:192
  v_cvt_pk_bf16_f32 v66, v100, v101
  v_mfma_f32_16x16x32_bf16 v[112:115], a[76:79], a[28:31], v[112:115]
  ds_read_b64_tr_b16 a[222:223], v33 offset:712
  v_cvt_pk_bf16_f32 v67, v102, v103
  v_mfma_f32_16x16x32_bf16 v[116:119], a[80:83], a[16:19], v[116:119]
  ds_read_b64_tr_b16 a[220:221], v33 offset:200
  v_add_f32 v96, v56, v8
  v_mfma_f32_16x16x32_bf16 v[116:119], a[84:87], a[20:23], v[116:119]
  v_add_f32 v97, v56, v9
  v_add_f32 v98, v56, v10
  v_mfma_f32_16x16x32_bf16 v[116:119], a[88:91], a[24:27], v[116:119]
  v_add_f32 v99, v56, v11
  v_add_f32 v100, v56, v12
  v_mfma_f32_16x16x32_bf16 v[116:119], a[92:95], a[28:31], v[116:119]
  v_add_f32 v101, v56, v13
  v_add_f32 v102, v56, v14
  v_smfmac_f32_16x16x64_bf16 v[80:83], v[36:39], v[64:71], v35
  s_waitcnt lgkmcnt(2)
  v_add_f32 v103, v56, v15
  v_mov_b64 v[76:77], 0
  v_mfma_f32_16x16x32_bf16 v[128:131], a[192:195], v[64:67], v[128:131]
  v_exp_f32 v112, v112
  v_mfma_f32_16x16x32_bf16 v[132:135], a[196:199], v[64:67], v[132:135]
  v_exp_f32 v113, v113
  v_mfma_f32_16x16x32_bf16 v[136:139], a[200:203], v[64:67], v[136:139]
  v_exp_f32 v114, v114
  v_mfma_f32_16x16x32_bf16 v[140:143], a[204:207], v[64:67], v[140:143]
  v_add_f32 v80, v80, v81
  v_add_f32 v82, v82, v83
  v_mfma_f32_16x16x32_bf16 v[144:147], a[208:211], v[64:67], v[144:147]
  v_add_f32 v80, v80, v82
  v_cvt_pk_bf16_f32 v72, v112, v113
  v_mfma_f32_16x16x32_bf16 v[148:151], a[212:215], v[64:67], v[148:151]
  v_rcp_f32 v2, v80
  v_mfma_f32_16x16x32_bf16 v[152:155], a[216:219], v[64:67], v[152:155]
  s_waitcnt lgkmcnt(0)
  v_mul_f32 v16, v16, v2
  v_fma_f32 v128, v128, v2, v16
  v_mfma_f32_16x16x32_bf16 v[156:159], a[220:223], v[64:67], v[156:159]
  v_fma_f32 v129, v129, v2, v16
  v_fma_f32 v130, v130, v2, v16
  v_mfma_f32_16x16x32_bf16 v[96:99], a[64:67], a[32:35], v[96:99]
  v_fma_f32 v131, v131, v2, v16
  v_cvt_pk_bf16_f32 v128, v128, v129
  v_mfma_f32_16x16x32_bf16 v[96:99], a[68:71], a[36:39], v[96:99]
  v_fma_f32 v132, v132, v2, v16
  v_fma_f32 v133, v133, v2, v16
  v_mfma_f32_16x16x32_bf16 v[96:99], a[72:75], a[40:43], v[96:99]
  v_fma_f32 v134, v134, v2, v16
  v_fma_f32 v135, v135, v2, v16
  v_mfma_f32_16x16x32_bf16 v[96:99], a[76:79], a[44:47], v[96:99]
  v_cvt_pk_bf16_f32 v129, v130, v131
  v_cvt_pk_bf16_f32 v130, v132, v133
  v_cvt_pk_bf16_f32 v131, v134, v135
  v_mfma_f32_16x16x32_bf16 v[100:103], a[80:83], a[32:35], v[100:103]
  buffer_store_dwordx4 v[128:131], v24, s[28:31], s60 offen offset:0 sc1
  v_fma_f32 v136, v136, v2, v16
  v_fma_f32 v137, v137, v2, v16
  v_fma_f32 v138, v138, v2, v16
  v_mfma_f32_16x16x32_bf16 v[100:103], a[84:87], a[36:39], v[100:103]
  v_fma_f32 v139, v139, v2, v16
  v_cvt_pk_bf16_f32 v136, v136, v137
  v_mfma_f32_16x16x32_bf16 v[100:103], a[88:91], a[40:43], v[100:103]
  v_exp_f32 v115, v115
  v_mfma_f32_16x16x32_bf16 v[100:103], a[92:95], a[44:47], v[100:103]
  v_exp_f32 v116, v116
  v_exp_f32 v117, v117
  v_exp_f32 v118, v118
  v_exp_f32 v119, v119
  v_fma_f32 v140, v140, v2, v16
  v_fma_f32 v141, v141, v2, v16
  v_fma_f32 v142, v142, v2, v16
  v_fma_f32 v143, v143, v2, v16
  v_cvt_pk_bf16_f32 v137, v138, v139
  v_cvt_pk_bf16_f32 v138, v140, v141
  v_cvt_pk_bf16_f32 v139, v142, v143
  v_cvt_pk_bf16_f32 v73, v114, v115
  v_cvt_pk_bf16_f32 v74, v116, v117
  v_cvt_pk_bf16_f32 v75, v118, v119
  v_mov_b64 v[78:79], 0
  s_nop 1
  v_smfmac_f32_16x16x64_bf16 v[84:87], v[36:39], v[72:79], v35
  buffer_store_dwordx4 v[136:139], v24, s[28:31], s60 offen offset:64 sc1
  v_fma_f32 v144, v144, v2, v16
  v_fma_f32 v145, v145, v2, v16
  v_fma_f32 v146, v146, v2, v16
  v_mfma_f32_16x16x32_bf16 v[160:163], a[192:195], v[72:75], v[160:163]
  v_fma_f32 v147, v147, v2, v16
  v_cvt_pk_bf16_f32 v144, v144, v145
  v_mfma_f32_16x16x32_bf16 v[164:167], a[196:199], v[72:75], v[164:167]
  v_fma_f32 v148, v148, v2, v16
  v_fma_f32 v149, v149, v2, v16
  v_mfma_f32_16x16x32_bf16 v[168:171], a[200:203], v[72:75], v[168:171]
  v_fma_f32 v150, v150, v2, v16
  v_fma_f32 v151, v151, v2, v16
  v_cvt_pk_bf16_f32 v145, v146, v147
  v_cvt_pk_bf16_f32 v146, v148, v149
  v_cvt_pk_bf16_f32 v147, v150, v151
  v_mfma_f32_16x16x32_bf16 v[172:175], a[204:207], v[72:75], v[172:175]
  buffer_store_dwordx4 v[144:147], v24, s[28:31], s60 offen offset:128 sc1
  v_fma_f32 v152, v152, v2, v16
  v_fma_f32 v153, v153, v2, v16
  v_fma_f32 v154, v154, v2, v16
  v_mfma_f32_16x16x32_bf16 v[176:179], a[208:211], v[72:75], v[176:179]
  v_fma_f32 v155, v155, v2, v16
  v_cvt_pk_bf16_f32 v152, v152, v153
  v_mfma_f32_16x16x32_bf16 v[180:183], a[212:215], v[72:75], v[180:183]
  v_fma_f32 v156, v156, v2, v16
  v_fma_f32 v157, v157, v2, v16
  v_mfma_f32_16x16x32_bf16 v[184:187], a[216:219], v[72:75], v[184:187]
  v_fma_f32 v158, v158, v2, v16
  v_fma_f32 v159, v159, v2, v16
  v_cvt_pk_bf16_f32 v153, v154, v155
  v_cvt_pk_bf16_f32 v154, v156, v157
  v_cvt_pk_bf16_f32 v155, v158, v159
  v_mfma_f32_16x16x32_bf16 v[188:191], a[220:223], v[72:75], v[188:191]
  buffer_store_dwordx4 v[152:155], v24, s[28:31], s60 offen offset:192 sc1
  v_add_f32 v112, v60, v8
  v_add_f32 v113, v60, v9
  v_add_f32 v114, v60, v10
  v_add_f32 v115, v60, v11
  v_add_f32 v84, v84, v85
  v_add_f32 v86, v86, v87
  v_mfma_f32_16x16x32_bf16 v[112:115], a[64:67], a[48:51], v[112:115]
  v_add_f32 v84, v84, v86
  v_add_f32 v116, v60, v12
  v_mfma_f32_16x16x32_bf16 v[112:115], a[68:71], a[52:55], v[112:115]
  v_rcp_f32 v3, v84
  v_mfma_f32_16x16x32_bf16 v[112:115], a[72:75], a[56:59], v[112:115]
  v_mul_f32 v17, v17, v3
  v_fma_f32 v160, v160, v3, v17
  v_mfma_f32_16x16x32_bf16 v[112:115], a[76:79], a[60:63], v[112:115]
  v_fma_f32 v161, v161, v3, v17
  v_fma_f32 v162, v162, v3, v17
  v_fma_f32 v163, v163, v3, v17
  v_cvt_pk_bf16_f32 v160, v160, v161
  v_fma_f32 v164, v164, v3, v17
  v_fma_f32 v165, v165, v3, v17
  v_fma_f32 v166, v166, v3, v17
  v_fma_f32 v167, v167, v3, v17
  v_cvt_pk_bf16_f32 v161, v162, v163
  v_cvt_pk_bf16_f32 v162, v164, v165
  v_cvt_pk_bf16_f32 v163, v166, v167
  v_add_f32 v117, v60, v13
  v_add_f32 v118, v60, v14
  v_add_f32 v119, v60, v15
  s_nop 1
  v_mfma_f32_16x16x32_bf16 v[116:119], a[80:83], a[48:51], v[116:119]
  buffer_store_dwordx4 v[160:163], v24, s[28:31], s61 offen offset:0 sc1
  v_fma_f32 v168, v168, v3, v17
  v_fma_f32 v169, v169, v3, v17
  v_fma_f32 v170, v170, v3, v17
  v_mfma_f32_16x16x32_bf16 v[116:119], a[84:87], a[52:55], v[116:119]
  v_fma_f32 v171, v171, v3, v17
  v_cvt_pk_bf16_f32 v168, v168, v169
  v_mfma_f32_16x16x32_bf16 v[116:119], a[88:91], a[56:59], v[116:119]
  v_exp_f32 v96, v96
  v_mfma_f32_16x16x32_bf16 v[116:119], a[92:95], a[60:63], v[116:119]
  v_exp_f32 v97, v97
  v_exp_f32 v98, v98
  v_exp_f32 v99, v99
  v_exp_f32 v100, v100
  v_exp_f32 v101, v101
  v_exp_f32 v102, v102
  v_exp_f32 v103, v103
  v_fma_f32 v172, v172, v3, v17
  v_fma_f32 v173, v173, v3, v17
  v_fma_f32 v174, v174, v3, v17
  v_fma_f32 v175, v175, v3, v17
  v_cvt_pk_bf16_f32 v169, v170, v171
  v_cvt_pk_bf16_f32 v170, v172, v173
  v_cvt_pk_bf16_f32 v171, v174, v175
  v_cvt_pk_bf16_f32 v64, v96, v97
  v_cvt_pk_bf16_f32 v65, v98, v99
  v_cvt_pk_bf16_f32 v66, v100, v101
  v_cvt_pk_bf16_f32 v67, v102, v103
  s_nop 1
  v_smfmac_f32_16x16x64_bf16 v[88:91], v[36:39], v[64:71], v35
  buffer_store_dwordx4 v[168:171], v24, s[28:31], s61 offen offset:64 sc1
  v_fma_f32 v176, v176, v3, v17
  v_fma_f32 v177, v177, v3, v17
  v_fma_f32 v178, v178, v3, v17
  v_mfma_f32_16x16x32_bf16 v[192:195], a[192:195], v[64:67], v[192:195]
  v_fma_f32 v179, v179, v3, v17
  v_cvt_pk_bf16_f32 v176, v176, v177
  v_mfma_f32_16x16x32_bf16 v[196:199], a[196:199], v[64:67], v[196:199]
  v_fma_f32 v180, v180, v3, v17
  v_fma_f32 v181, v181, v3, v17
  v_mfma_f32_16x16x32_bf16 v[200:203], a[200:203], v[64:67], v[200:203]
  v_fma_f32 v182, v182, v3, v17
  v_fma_f32 v183, v183, v3, v17
  v_cvt_pk_bf16_f32 v177, v178, v179
  v_cvt_pk_bf16_f32 v178, v180, v181
  v_cvt_pk_bf16_f32 v179, v182, v183
  v_mfma_f32_16x16x32_bf16 v[204:207], a[204:207], v[64:67], v[204:207]
  buffer_store_dwordx4 v[176:179], v24, s[28:31], s61 offen offset:128 sc1
  v_fma_f32 v184, v184, v3, v17
  v_fma_f32 v185, v185, v3, v17
  v_fma_f32 v186, v186, v3, v17
  v_mfma_f32_16x16x32_bf16 v[208:211], a[208:211], v[64:67], v[208:211]
  v_fma_f32 v187, v187, v3, v17
  v_cvt_pk_bf16_f32 v184, v184, v185
  v_mfma_f32_16x16x32_bf16 v[212:215], a[212:215], v[64:67], v[212:215]
  v_fma_f32 v188, v188, v3, v17
  v_fma_f32 v189, v189, v3, v17
  v_mfma_f32_16x16x32_bf16 v[216:219], a[216:219], v[64:67], v[216:219]
  v_fma_f32 v190, v190, v3, v17
  v_fma_f32 v191, v191, v3, v17
  v_cvt_pk_bf16_f32 v185, v186, v187
  v_cvt_pk_bf16_f32 v186, v188, v189
  v_cvt_pk_bf16_f32 v187, v190, v191
  v_mfma_f32_16x16x32_bf16 v[220:223], a[220:223], v[64:67], v[220:223]
  buffer_store_dwordx4 v[184:187], v24, s[28:31], s61 offen offset:192 sc1
  v_exp_f32 v112, v112
  v_exp_f32 v113, v113
  v_exp_f32 v114, v114
  v_exp_f32 v115, v115
  v_exp_f32 v116, v116
  v_exp_f32 v117, v117
  v_exp_f32 v118, v118
  v_exp_f32 v119, v119
  v_cvt_pk_bf16_f32 v72, v112, v113
  v_cvt_pk_bf16_f32 v73, v114, v115
  v_cvt_pk_bf16_f32 v74, v116, v117
  v_cvt_pk_bf16_f32 v75, v118, v119
  v_add_f32 v88, v88, v89
  v_add_f32 v90, v90, v91
  v_smfmac_f32_16x16x64_bf16 v[92:95], v[36:39], v[72:79], v35
  v_add_f32 v88, v88, v90
  v_mfma_f32_16x16x32_bf16 v[224:227], a[192:195], v[72:75], v[224:227]
  v_rcp_f32 v4, v88
  v_mfma_f32_16x16x32_bf16 v[228:231], a[196:199], v[72:75], v[228:231]
  v_mul_f32 v18, v18, v4
  v_fma_f32 v192, v192, v4, v18
  v_mfma_f32_16x16x32_bf16 v[232:235], a[200:203], v[72:75], v[232:235]
  v_fma_f32 v193, v193, v4, v18
  v_fma_f32 v194, v194, v4, v18
  v_mfma_f32_16x16x32_bf16 v[236:239], a[204:207], v[72:75], v[236:239]
  v_fma_f32 v195, v195, v4, v18
  v_fma_f32 v196, v196, v4, v18
  v_mfma_f32_16x16x32_bf16 v[240:243], a[208:211], v[72:75], v[240:243]
  v_fma_f32 v197, v197, v4, v18
  v_fma_f32 v198, v198, v4, v18
  v_mfma_f32_16x16x32_bf16 v[244:247], a[212:215], v[72:75], v[244:247]
  v_fma_f32 v199, v199, v4, v18
  v_cvt_pk_bf16_f32 v192, v192, v193
  v_mfma_f32_16x16x32_bf16 v[248:251], a[216:219], v[72:75], v[248:251]
  v_cvt_pk_bf16_f32 v193, v194, v195
  v_cvt_pk_bf16_f32 v194, v196, v197
  v_mfma_f32_16x16x32_bf16 v[252:255], a[220:223], v[72:75], v[252:255]
  v_cvt_pk_bf16_f32 v195, v198, v199
  buffer_store_dwordx4 v[192:195], v24, s[28:31], s62 offen offset:0 sc1
  v_fma_f32 v200, v200, v4, v18
  v_fma_f32 v201, v201, v4, v18
  v_fma_f32 v202, v202, v4, v18
  v_fma_f32 v203, v203, v4, v18
  v_fma_f32 v204, v204, v4, v18
  v_fma_f32 v205, v205, v4, v18
  v_fma_f32 v206, v206, v4, v18
  v_fma_f32 v207, v207, v4, v18
  v_cvt_pk_bf16_f32 v200, v200, v201
  v_cvt_pk_bf16_f32 v201, v202, v203
  v_cvt_pk_bf16_f32 v202, v204, v205
  v_cvt_pk_bf16_f32 v203, v206, v207
  buffer_store_dwordx4 v[200:203], v24, s[28:31], s62 offen offset:64 sc1
  v_fma_f32 v208, v208, v4, v18
  v_fma_f32 v209, v209, v4, v18
  v_fma_f32 v210, v210, v4, v18
  v_fma_f32 v211, v211, v4, v18
  v_fma_f32 v212, v212, v4, v18
  v_fma_f32 v213, v213, v4, v18
  v_fma_f32 v214, v214, v4, v18
  v_fma_f32 v215, v215, v4, v18
  v_cvt_pk_bf16_f32 v208, v208, v209
  v_cvt_pk_bf16_f32 v209, v210, v211
  v_cvt_pk_bf16_f32 v210, v212, v213
  v_cvt_pk_bf16_f32 v211, v214, v215
  buffer_store_dwordx4 v[208:211], v24, s[28:31], s62 offen offset:128 sc1
  v_fma_f32 v216, v216, v4, v18
  v_fma_f32 v217, v217, v4, v18
  v_fma_f32 v218, v218, v4, v18
  v_fma_f32 v219, v219, v4, v18
  v_fma_f32 v220, v220, v4, v18
  v_fma_f32 v221, v221, v4, v18
  v_fma_f32 v222, v222, v4, v18
  v_fma_f32 v223, v223, v4, v18
  v_cvt_pk_bf16_f32 v216, v216, v217
  v_cvt_pk_bf16_f32 v217, v218, v219
  v_cvt_pk_bf16_f32 v218, v220, v221
  v_cvt_pk_bf16_f32 v219, v222, v223
  buffer_store_dwordx4 v[216:219], v24, s[28:31], s62 offen offset:192 sc1
  v_add_f32 v92, v92, v93
  v_add_f32 v94, v94, v95
  v_add_f32 v92, v92, v94
  v_rcp_f32 v5, v92
  s_nop 0
  v_mul_f32 v19, v19, v5
  v_fma_f32 v224, v224, v5, v19
  v_fma_f32 v225, v225, v5, v19
  v_fma_f32 v226, v226, v5, v19
  v_fma_f32 v227, v227, v5, v19
  v_fma_f32 v228, v228, v5, v19
  v_fma_f32 v229, v229, v5, v19
  v_fma_f32 v230, v230, v5, v19
  v_fma_f32 v231, v231, v5, v19
  v_cvt_pk_bf16_f32 v224, v224, v225
  v_cvt_pk_bf16_f32 v225, v226, v227
  v_cvt_pk_bf16_f32 v226, v228, v229
  v_cvt_pk_bf16_f32 v227, v230, v231
  buffer_store_dwordx4 v[224:227], v24, s[28:31], s63 offen offset:0 sc1
  v_fma_f32 v232, v232, v5, v19
  v_fma_f32 v233, v233, v5, v19
  v_fma_f32 v234, v234, v5, v19
  v_fma_f32 v235, v235, v5, v19
  v_fma_f32 v236, v236, v5, v19
  v_fma_f32 v237, v237, v5, v19
  v_fma_f32 v238, v238, v5, v19
  v_fma_f32 v239, v239, v5, v19
  v_cvt_pk_bf16_f32 v232, v232, v233
  v_cvt_pk_bf16_f32 v233, v234, v235
  v_cvt_pk_bf16_f32 v234, v236, v237
  v_cvt_pk_bf16_f32 v235, v238, v239
  buffer_store_dwordx4 v[232:235], v24, s[28:31], s63 offen offset:64 sc1
  v_fma_f32 v240, v240, v5, v19
  v_fma_f32 v241, v241, v5, v19
  v_fma_f32 v242, v242, v5, v19
  v_fma_f32 v243, v243, v5, v19
  v_fma_f32 v244, v244, v5, v19
  v_fma_f32 v245, v245, v5, v19
  v_fma_f32 v246, v246, v5, v19
  v_fma_f32 v247, v247, v5, v19
  v_cvt_pk_bf16_f32 v240, v240, v241
  v_cvt_pk_bf16_f32 v241, v242, v243
  v_cvt_pk_bf16_f32 v242, v244, v245
  v_cvt_pk_bf16_f32 v243, v246, v247
  buffer_store_dwordx4 v[240:243], v24, s[28:31], s63 offen offset:128 sc1
  v_fma_f32 v248, v248, v5, v19
  v_fma_f32 v249, v249, v5, v19
  v_fma_f32 v250, v250, v5, v19
  v_fma_f32 v251, v251, v5, v19
  v_fma_f32 v252, v252, v5, v19
  v_fma_f32 v253, v253, v5, v19
  v_fma_f32 v254, v254, v5, v19
  v_fma_f32 v255, v255, v5, v19
  v_cvt_pk_bf16_f32 v248, v248, v249
  v_cvt_pk_bf16_f32 v249, v250, v251
  v_cvt_pk_bf16_f32 v250, v252, v253
  v_cvt_pk_bf16_f32 v251, v254, v255
  buffer_store_dwordx4 v[248:251], v24, s[28:31], s63 offen offset:192 sc1
  v_add_f32 v6, v80, v84
  v_add_f32 v7, v88, v92
  v_add_f32 v7, v6, v7
  v_cmp_nge_f32 vcc, 0x53800000, v7
  s_nop 0
  s_cbranch_vccnz L_slow
  s_endpgm
L_slow0:
  s_add_u32 m0, s55, 32768
  s_nop 0
  buffer_load_dwordx4 v16, s[20:23], s62 offen offset:0 nt lds
  buffer_load_dwordx4 v17, s[20:23], s62 offen offset:1024 nt lds
  buffer_load_dwordx4 v18, s[20:23], s62 offen offset:2048 nt lds
  buffer_load_dwordx4 v19, s[20:23], s62 offen offset:3072 nt lds
  s_add_u32 m0, s55, 49152
  s_nop 0
  buffer_load_dwordx4 v16, s[20:23], s63 offen offset:0 nt lds
  buffer_load_dwordx4 v17, s[20:23], s63 offen offset:1024 nt lds
  buffer_load_dwordx4 v18, s[20:23], s63 offen offset:2048 nt lds
  buffer_load_dwordx4 v19, s[20:23], s63 offen offset:3072 nt lds
  s_waitcnt vmcnt(0)
  ds_read_b128 v[224:227], v4 offset:0
  ds_read_b128 v[228:231], v5 offset:0
  ds_read_b128 v[232:235], v6 offset:0
  ds_read_b128 v[236:239], v7 offset:0
  s_waitcnt lgkmcnt(0)
  v_lshlrev_b32 v240, 16, v224
  v_and_b32 v241, 0xffff0000, v224
  v_pk_mul_f32 v[240:241], v[240:241], s[56:57]
  v_cvt_pk_bf16_f32 v240, v240, v241
  v_accvgpr_write_b32 a0, v240
  v_lshlrev_b32 v242, 16, v225
  v_and_b32 v243, 0xffff0000, v225
  v_pk_mul_f32 v[242:243], v[242:243], s[56:57]
  v_cvt_pk_bf16_f32 v242, v242, v243
  v_accvgpr_write_b32 a1, v242
  v_lshlrev_b32 v244, 16, v226
  v_and_b32 v245, 0xffff0000, v226
  v_pk_mul_f32 v[244:245], v[244:245], s[56:57]
  v_cvt_pk_bf16_f32 v244, v244, v245
  v_accvgpr_write_b32 a2, v244
  v_lshlrev_b32 v246, 16, v227
  v_and_b32 v247, 0xffff0000, v227
  v_pk_mul_f32 v[246:247], v[246:247], s[56:57]
  v_cvt_pk_bf16_f32 v246, v246, v247
  v_accvgpr_write_b32 a3, v246
  v_lshlrev_b32 v240, 16, v228
  v_and_b32 v241, 0xffff0000, v228
  v_pk_mul_f32 v[240:241], v[240:241], s[56:57]
  v_cvt_pk_bf16_f32 v240, v240, v241
  v_accvgpr_write_b32 a4, v240
  v_lshlrev_b32 v242, 16, v229
  v_and_b32 v243, 0xffff0000, v229
  v_pk_mul_f32 v[242:243], v[242:243], s[56:57]
  v_cvt_pk_bf16_f32 v242, v242, v243
  v_accvgpr_write_b32 a5, v242
  v_lshlrev_b32 v244, 16, v230
  v_and_b32 v245, 0xffff0000, v230
  v_pk_mul_f32 v[244:245], v[244:245], s[56:57]
  v_cvt_pk_bf16_f32 v244, v244, v245
  v_accvgpr_write_b32 a6, v244
  v_lshlrev_b32 v246, 16, v231
  v_and_b32 v247, 0xffff0000, v231
  v_pk_mul_f32 v[246:247], v[246:247], s[56:57]
  v_cvt_pk_bf16_f32 v246, v246, v247
  v_accvgpr_write_b32 a7, v246
  v_lshlrev_b32 v240, 16, v232
  v_and_b32 v241, 0xffff0000, v232
  v_pk_mul_f32 v[240:241], v[240:241], s[56:57]
  v_cvt_pk_bf16_f32 v240, v240, v241
  v_accvgpr_write_b32 a8, v240
  v_lshlrev_b32 v242, 16, v233
  v_and_b32 v243, 0xffff0000, v233
  v_pk_mul_f32 v[242:243], v[242:243], s[56:57]
  v_cvt_pk_bf16_f32 v242, v242, v243
  v_accvgpr_write_b32 a9, v242
  v_lshlrev_b32 v244, 16, v234
  v_and_b32 v245, 0xffff0000, v234
  v_pk_mul_f32 v[244:245], v[244:245], s[56:57]
  v_cvt_pk_bf16_f32 v244, v244, v245
  v_accvgpr_write_b32 a10, v244
  v_lshlrev_b32 v246, 16, v235
  v_and_b32 v247, 0xffff0000, v235
  v_pk_mul_f32 v[246:247], v[246:247], s[56:57]
  v_cvt_pk_bf16_f32 v246, v246, v247
  v_accvgpr_write_b32 a11, v246
  v_lshlrev_b32 v240, 16, v236
  v_and_b32 v241, 0xffff0000, v236
  v_pk_mul_f32 v[240:241], v[240:241], s[56:57]
  v_cvt_pk_bf16_f32 v240, v240, v241
  v_accvgpr_write_b32 a12, v240
  v_lshlrev_b32 v242, 16, v237
  v_and_b32 v243, 0xffff0000, v237
  v_pk_mul_f32 v[242:243], v[242:243], s[56:57]
  v_cvt_pk_bf16_f32 v242, v242, v243
  v_accvgpr_write_b32 a13, v242
  v_lshlrev_b32 v244, 16, v238
  v_and_b32 v245, 0xffff0000, v238
  v_pk_mul_f32 v[244:245], v[244:245], s[56:57]
  v_cvt_pk_bf16_f32 v244, v244, v245
  v_accvgpr_write_b32 a14, v244
  v_lshlrev_b32 v246, 16, v239
  v_and_b32 v247, 0xffff0000, v239
  v_pk_mul_f32 v[246:247], v[246:247], s[56:57]
  v_cvt_pk_bf16_f32 v246, v246, v247
  v_accvgpr_write_b32 a15, v246
  ds_read_b128 v[224:227], v4 offset:16384
  ds_read_b128 v[228:231], v5 offset:16384
  ds_read_b128 v[232:235], v6 offset:16384
  ds_read_b128 v[236:239], v7 offset:16384
  s_waitcnt lgkmcnt(0)
  v_lshlrev_b32 v240, 16, v224
  v_and_b32 v241, 0xffff0000, v224
  v_pk_mul_f32 v[240:241], v[240:241], s[56:57]
  v_cvt_pk_bf16_f32 v240, v240, v241
  v_accvgpr_write_b32 a16, v240
  v_lshlrev_b32 v242, 16, v225
  v_and_b32 v243, 0xffff0000, v225
  v_pk_mul_f32 v[242:243], v[242:243], s[56:57]
  v_cvt_pk_bf16_f32 v242, v242, v243
  v_accvgpr_write_b32 a17, v242
  v_lshlrev_b32 v244, 16, v226
  v_and_b32 v245, 0xffff0000, v226
  v_pk_mul_f32 v[244:245], v[244:245], s[56:57]
  v_cvt_pk_bf16_f32 v244, v244, v245
  v_accvgpr_write_b32 a18, v244
  v_lshlrev_b32 v246, 16, v227
  v_and_b32 v247, 0xffff0000, v227
  v_pk_mul_f32 v[246:247], v[246:247], s[56:57]
  v_cvt_pk_bf16_f32 v246, v246, v247
  v_accvgpr_write_b32 a19, v246
  v_lshlrev_b32 v240, 16, v228
  v_and_b32 v241, 0xffff0000, v228
  v_pk_mul_f32 v[240:241], v[240:241], s[56:57]
  v_cvt_pk_bf16_f32 v240, v240, v241
  v_accvgpr_write_b32 a20, v240
  v_lshlrev_b32 v242, 16, v229
  v_and_b32 v243, 0xffff0000, v229
  v_pk_mul_f32 v[242:243], v[242:243], s[56:57]
  v_cvt_pk_bf16_f32 v242, v242, v243
  v_accvgpr_write_b32 a21, v242
  v_lshlrev_b32 v244, 16, v230
  v_and_b32 v245, 0xffff0000, v230
  v_pk_mul_f32 v[244:245], v[244:245], s[56:57]
  v_cvt_pk_bf16_f32 v244, v244, v245
  v_accvgpr_write_b32 a22, v244
  v_lshlrev_b32 v246, 16, v231
  v_and_b32 v247, 0xffff0000, v231
  v_pk_mul_f32 v[246:247], v[246:247], s[56:57]
  v_cvt_pk_bf16_f32 v246, v246, v247
  v_accvgpr_write_b32 a23, v246
  v_lshlrev_b32 v240, 16, v232
  v_and_b32 v241, 0xffff0000, v232
  v_pk_mul_f32 v[240:241], v[240:241], s[56:57]
  v_cvt_pk_bf16_f32 v240, v240, v241
  v_accvgpr_write_b32 a24, v240
  v_lshlrev_b32 v242, 16, v233
  v_and_b32 v243, 0xffff0000, v233
  v_pk_mul_f32 v[242:243], v[242:243], s[56:57]
  v_cvt_pk_bf16_f32 v242, v242, v243
  v_accvgpr_write_b32 a25, v242
  v_lshlrev_b32 v244, 16, v234
  v_and_b32 v245, 0xffff0000, v234
  v_pk_mul_f32 v[244:245], v[244:245], s[56:57]
  v_cvt_pk_bf16_f32 v244, v244, v245
  v_accvgpr_write_b32 a26, v244
  v_lshlrev_b32 v246, 16, v235
  v_and_b32 v247, 0xffff0000, v235
  v_pk_mul_f32 v[246:247], v[246:247], s[56:57]
  v_cvt_pk_bf16_f32 v246, v246, v247
  v_accvgpr_write_b32 a27, v246
  v_lshlrev_b32 v240, 16, v236
  v_and_b32 v241, 0xffff0000, v236
  v_pk_mul_f32 v[240:241], v[240:241], s[56:57]
  v_cvt_pk_bf16_f32 v240, v240, v241
  v_accvgpr_write_b32 a28, v240
  v_lshlrev_b32 v242, 16, v237
  v_and_b32 v243, 0xffff0000, v237
  v_pk_mul_f32 v[242:243], v[242:243], s[56:57]
  v_cvt_pk_bf16_f32 v242, v242, v243
  v_accvgpr_write_b32 a29, v242
  v_lshlrev_b32 v244, 16, v238
  v_and_b32 v245, 0xffff0000, v238
  v_pk_mul_f32 v[244:245], v[244:245], s[56:57]
  v_cvt_pk_bf16_f32 v244, v244, v245
  v_accvgpr_write_b32 a30, v244
  v_lshlrev_b32 v246, 16, v239
  v_and_b32 v247, 0xffff0000, v239
  v_pk_mul_f32 v[246:247], v[246:247], s[56:57]
  v_cvt_pk_bf16_f32 v246, v246, v247
  v_accvgpr_write_b32 a31, v246
  ds_read_b128 v[224:227], v4 offset:32768
  ds_read_b128 v[228:231], v5 offset:32768
  ds_read_b128 v[232:235], v6 offset:32768
  ds_read_b128 v[236:239], v7 offset:32768
  s_waitcnt lgkmcnt(0)
  v_lshlrev_b32 v240, 16, v224
  v_and_b32 v241, 0xffff0000, v224
  v_pk_mul_f32 v[240:241], v[240:241], s[56:57]
  v_cvt_pk_bf16_f32 v240, v240, v241
  v_accvgpr_write_b32 a32, v240
  v_lshlrev_b32 v242, 16, v225
  v_and_b32 v243, 0xffff0000, v225
  v_pk_mul_f32 v[242:243], v[242:243], s[56:57]
  v_cvt_pk_bf16_f32 v242, v242, v243
  v_accvgpr_write_b32 a33, v242
  v_lshlrev_b32 v244, 16, v226
  v_and_b32 v245, 0xffff0000, v226
  v_pk_mul_f32 v[244:245], v[244:245], s[56:57]
  v_cvt_pk_bf16_f32 v244, v244, v245
  v_accvgpr_write_b32 a34, v244
  v_lshlrev_b32 v246, 16, v227
  v_and_b32 v247, 0xffff0000, v227
  v_pk_mul_f32 v[246:247], v[246:247], s[56:57]
  v_cvt_pk_bf16_f32 v246, v246, v247
  v_accvgpr_write_b32 a35, v246
  v_lshlrev_b32 v240, 16, v228
  v_and_b32 v241, 0xffff0000, v228
  v_pk_mul_f32 v[240:241], v[240:241], s[56:57]
  v_cvt_pk_bf16_f32 v240, v240, v241
  v_accvgpr_write_b32 a36, v240
  v_lshlrev_b32 v242, 16, v229
  v_and_b32 v243, 0xffff0000, v229
  v_pk_mul_f32 v[242:243], v[242:243], s[56:57]
  v_cvt_pk_bf16_f32 v242, v242, v243
  v_accvgpr_write_b32 a37, v242
  v_lshlrev_b32 v244, 16, v230
  v_and_b32 v245, 0xffff0000, v230
  v_pk_mul_f32 v[244:245], v[244:245], s[56:57]
  v_cvt_pk_bf16_f32 v244, v244, v245
  v_accvgpr_write_b32 a38, v244
  v_lshlrev_b32 v246, 16, v231
  v_and_b32 v247, 0xffff0000, v231
  v_pk_mul_f32 v[246:247], v[246:247], s[56:57]
  v_cvt_pk_bf16_f32 v246, v246, v247
  v_accvgpr_write_b32 a39, v246
  v_lshlrev_b32 v240, 16, v232
  v_and_b32 v241, 0xffff0000, v232
  v_pk_mul_f32 v[240:241], v[240:241], s[56:57]
  v_cvt_pk_bf16_f32 v240, v240, v241
  v_accvgpr_write_b32 a40, v240
  v_lshlrev_b32 v242, 16, v233
  v_and_b32 v243, 0xffff0000, v233
  v_pk_mul_f32 v[242:243], v[242:243], s[56:57]
  v_cvt_pk_bf16_f32 v242, v242, v243
  v_accvgpr_write_b32 a41, v242
  v_lshlrev_b32 v244, 16, v234
  v_and_b32 v245, 0xffff0000, v234
  v_pk_mul_f32 v[244:245], v[244:245], s[56:57]
  v_cvt_pk_bf16_f32 v244, v244, v245
  v_accvgpr_write_b32 a42, v244
  v_lshlrev_b32 v246, 16, v235
  v_and_b32 v247, 0xffff0000, v235
  v_pk_mul_f32 v[246:247], v[246:247], s[56:57]
  v_cvt_pk_bf16_f32 v246, v246, v247
  v_accvgpr_write_b32 a43, v246
  v_lshlrev_b32 v240, 16, v236
  v_and_b32 v241, 0xffff0000, v236
  v_pk_mul_f32 v[240:241], v[240:241], s[56:57]
  v_cvt_pk_bf16_f32 v240, v240, v241
  v_accvgpr_write_b32 a44, v240
  v_lshlrev_b32 v242, 16, v237
  v_and_b32 v243, 0xffff0000, v237
  v_pk_mul_f32 v[242:243], v[242:243], s[56:57]
  v_cvt_pk_bf16_f32 v242, v242, v243
  v_accvgpr_write_b32 a45, v242
  v_lshlrev_b32 v244, 16, v238
  v_and_b32 v245, 0xffff0000, v238
  v_pk_mul_f32 v[244:245], v[244:245], s[56:57]
  v_cvt_pk_bf16_f32 v244, v244, v245
  v_accvgpr_write_b32 a46, v244
  v_lshlrev_b32 v246, 16, v239
  v_and_b32 v247, 0xffff0000, v239
  v_pk_mul_f32 v[246:247], v[246:247], s[56:57]
  v_cvt_pk_bf16_f32 v246, v246, v247
  v_accvgpr_write_b32 a47, v246
  ds_read_b128 v[224:227], v4 offset:49152
  ds_read_b128 v[228:231], v5 offset:49152
  ds_read_b128 v[232:235], v6 offset:49152
  ds_read_b128 v[236:239], v7 offset:49152
  s_waitcnt lgkmcnt(0)
  v_lshlrev_b32 v240, 16, v224
  v_and_b32 v241, 0xffff0000, v224
  v_pk_mul_f32 v[240:241], v[240:241], s[56:57]
  v_cvt_pk_bf16_f32 v240, v240, v241
  v_accvgpr_write_b32 a48, v240
  v_lshlrev_b32 v242, 16, v225
  v_and_b32 v243, 0xffff0000, v225
  v_pk_mul_f32 v[242:243], v[242:243], s[56:57]
  v_cvt_pk_bf16_f32 v242, v242, v243
  v_accvgpr_write_b32 a49, v242
  v_lshlrev_b32 v244, 16, v226
  v_and_b32 v245, 0xffff0000, v226
  v_pk_mul_f32 v[244:245], v[244:245], s[56:57]
  v_cvt_pk_bf16_f32 v244, v244, v245
  v_accvgpr_write_b32 a50, v244
  v_lshlrev_b32 v246, 16, v227
  v_and_b32 v247, 0xffff0000, v227
  v_pk_mul_f32 v[246:247], v[246:247], s[56:57]
  v_cvt_pk_bf16_f32 v246, v246, v247
  v_accvgpr_write_b32 a51, v246
  v_lshlrev_b32 v240, 16, v228
  v_and_b32 v241, 0xffff0000, v228
  v_pk_mul_f32 v[240:241], v[240:241], s[56:57]
  v_cvt_pk_bf16_f32 v240, v240, v241
  v_accvgpr_write_b32 a52, v240
  v_lshlrev_b32 v242, 16, v229
  v_and_b32 v243, 0xffff0000, v229
  v_pk_mul_f32 v[242:243], v[242:243], s[56:57]
  v_cvt_pk_bf16_f32 v242, v242, v243
  v_accvgpr_write_b32 a53, v242
  v_lshlrev_b32 v244, 16, v230
  v_and_b32 v245, 0xffff0000, v230
  v_pk_mul_f32 v[244:245], v[244:245], s[56:57]
  v_cvt_pk_bf16_f32 v244, v244, v245
  v_accvgpr_write_b32 a54, v244
  v_lshlrev_b32 v246, 16, v231
  v_and_b32 v247, 0xffff0000, v231
  v_pk_mul_f32 v[246:247], v[246:247], s[56:57]
  v_cvt_pk_bf16_f32 v246, v246, v247
  v_accvgpr_write_b32 a55, v246
  v_lshlrev_b32 v240, 16, v232
  v_and_b32 v241, 0xffff0000, v232
  v_pk_mul_f32 v[240:241], v[240:241], s[56:57]
  v_cvt_pk_bf16_f32 v240, v240, v241
  v_accvgpr_write_b32 a56, v240
  v_lshlrev_b32 v242, 16, v233
  v_and_b32 v243, 0xffff0000, v233
  v_pk_mul_f32 v[242:243], v[242:243], s[56:57]
  v_cvt_pk_bf16_f32 v242, v242, v243
  v_accvgpr_write_b32 a57, v242
  v_lshlrev_b32 v244, 16, v234
  v_and_b32 v245, 0xffff0000, v234
  v_pk_mul_f32 v[244:245], v[244:245], s[56:57]
  v_cvt_pk_bf16_f32 v244, v244, v245
  v_accvgpr_write_b32 a58, v244
  v_lshlrev_b32 v246, 16, v235
  v_and_b32 v247, 0xffff0000, v235
  v_pk_mul_f32 v[246:247], v[246:247], s[56:57]
  v_cvt_pk_bf16_f32 v246, v246, v247
  v_accvgpr_write_b32 a59, v246
  v_lshlrev_b32 v240, 16, v236
  v_and_b32 v241, 0xffff0000, v236
  v_pk_mul_f32 v[240:241], v[240:241], s[56:57]
  v_cvt_pk_bf16_f32 v240, v240, v241
  v_accvgpr_write_b32 a60, v240
  v_lshlrev_b32 v242, 16, v237
  v_and_b32 v243, 0xffff0000, v237
  v_pk_mul_f32 v[242:243], v[242:243], s[56:57]
  v_cvt_pk_bf16_f32 v242, v242, v243
  v_accvgpr_write_b32 a61, v242
  v_lshlrev_b32 v244, 16, v238
  v_and_b32 v245, 0xffff0000, v238
  v_pk_mul_f32 v[244:245], v[244:245], s[56:57]
  v_cvt_pk_bf16_f32 v244, v244, v245
  v_accvgpr_write_b32 a62, v244
  v_lshlrev_b32 v246, 16, v239
  v_and_b32 v247, 0xffff0000, v239
  v_pk_mul_f32 v[246:247], v[246:247], s[56:57]
  v_cvt_pk_bf16_f32 v246, v246, v247
  v_accvgpr_write_b32 a63, v246
  s_mov_b32 s51, 52608
  s_mul_i32 s58, s44, 8768
  s_branch L_slow1
L_slow:
  s_mov_b32 s51, 105216
  s_mul_i32 s58, s44, 14336
L_slow1:
  s_waitcnt vmcnt(0) lgkmcnt(0)
  s_add_u32 s51, s51, s58
  v_add_u32 v34, s51, v27
  s_sub_u32 s58, s51, 52608
  v_add_u32 v33, s58, v26
  s_mov_b32 s52, 0
  v_mov_b64 v[128:129], 0
  v_mov_b64 v[130:131], 0
  v_mov_b64 v[132:133], 0
  v_mov_b64 v[134:135], 0
  v_mov_b64 v[136:137], 0
  v_mov_b64 v[138:139], 0
  v_mov_b64 v[140:141], 0
  v_mov_b64 v[142:143], 0
  v_mov_b64 v[144:145], 0
  v_mov_b64 v[146:147], 0
  v_mov_b64 v[148:149], 0
  v_mov_b64 v[150:151], 0
  v_mov_b64 v[152:153], 0
  v_mov_b64 v[154:155], 0
  v_mov_b64 v[156:157], 0
  v_mov_b64 v[158:159], 0
  v_mov_b64 v[160:161], 0
  v_mov_b64 v[162:163], 0
  v_mov_b64 v[164:165], 0
  v_mov_b64 v[166:167], 0
  v_mov_b64 v[168:169], 0
  v_mov_b64 v[170:171], 0
  v_mov_b64 v[172:173], 0
  v_mov_b64 v[174:175], 0
  v_mov_b64 v[176:177], 0
  v_mov_b64 v[178:179], 0
  v_mov_b64 v[180:181], 0
  v_mov_b64 v[182:183], 0
  v_mov_b64 v[184:185], 0
  v_mov_b64 v[186:187], 0
  v_mov_b64 v[188:189], 0
  v_mov_b64 v[190:191], 0
  v_mov_b64 v[192:193], 0
  v_mov_b64 v[194:195], 0
  v_mov_b64 v[196:197], 0
  v_mov_b64 v[198:199], 0
  v_mov_b64 v[200:201], 0
  v_mov_b64 v[202:203], 0
  v_mov_b64 v[204:205], 0
  v_mov_b64 v[206:207], 0
  v_mov_b64 v[208:209], 0
  v_mov_b64 v[210:211], 0
  v_mov_b64 v[212:213], 0
  v_mov_b64 v[214:215], 0
  v_mov_b64 v[216:217], 0
  v_mov_b64 v[218:219], 0
  v_mov_b64 v[220:221], 0
  v_mov_b64 v[222:223], 0
  v_mov_b64 v[224:225], 0
  v_mov_b64 v[226:227], 0
  v_mov_b64 v[228:229], 0
  v_mov_b64 v[230:231], 0
  v_mov_b64 v[232:233], 0
  v_mov_b64 v[234:235], 0
  v_mov_b64 v[236:237], 0
  v_mov_b64 v[238:239], 0
  v_mov_b64 v[240:241], 0
  v_mov_b64 v[242:243], 0
  v_mov_b64 v[244:245], 0
  v_mov_b64 v[246:247], 0
  v_mov_b64 v[248:249], 0
  v_mov_b64 v[250:251], 0
  v_mov_b64 v[252:253], 0
  v_mov_b64 v[254:255], 0
  v_mov_b32 v8, 0xff800000
  v_mov_b32 v12, 0
  v_mov_b32 v9, 0xff800000
  v_mov_b32 v13, 0
  v_mov_b32 v10, 0xff800000
  v_mov_b32 v14, 0
  v_mov_b32 v11, 0xff800000
  v_mov_b32 v15, 0
L_sloop:
  s_lshl_b32 s58, s52, 3
  s_load_dwordx2 s[98:99], s[10:11], s58
  s_waitcnt lgkmcnt(0)
  s_lshl_b32 s98, s98, 17
  s_lshl_b32 s99, s99, 17
  s_mov_b32 m0, s51
  s_nop 0
  buffer_load_dwordx4 v28, s[36:39], s98 offen offset:0 lds
  buffer_load_dwordx4 v29, s[36:39], s98 offen offset:1088 lds
  buffer_load_dwordx4 v30, s[36:39], s98 offen offset:2176 lds
  buffer_load_dwordx4 v31, s[36:39], s98 offen offset:3264 lds
  s_add_u32 m0, s51, 4384
  s_nop 0
  buffer_load_dwordx4 v28, s[36:39], s99 offen offset:0 lds
  buffer_load_dwordx4 v29, s[36:39], s99 offen offset:1088 lds
  buffer_load_dwordx4 v30, s[36:39], s99 offen offset:2176 lds
  buffer_load_dwordx4 v31, s[36:39], s99 offen offset:3264 lds
  s_waitcnt vmcnt(0)
  ds_read_b128 a[64:67], v34 offset:0
  ds_read_b128 a[68:71], v34 offset:64
  ds_read_b128 a[72:75], v34 offset:128
  ds_read_b128 a[76:79], v34 offset:192
  ds_read_b128 a[80:83], v34 offset:512
  ds_read_b128 a[84:87], v34 offset:576
  ds_read_b128 a[88:91], v34 offset:640
  ds_read_b128 a[92:95], v34 offset:704
  s_waitcnt lgkmcnt(0)
  s_mov_b32 m0, s51
  s_nop 0
  buffer_load_dwordx4 v28, s[40:43], s98 offen offset:0 lds
  buffer_load_dwordx4 v29, s[40:43], s98 offen offset:1088 lds
  buffer_load_dwordx4 v30, s[40:43], s98 offen offset:2176 lds
  buffer_load_dwordx4 v31, s[40:43], s98 offen offset:3264 lds
  s_add_u32 m0, s51, 4360
  s_nop 0
  buffer_load_dwordx4 v28, s[40:43], s99 offen offset:0 lds
  buffer_load_dwordx4 v29, s[40:43], s99 offen offset:1088 lds
  buffer_load_dwordx4 v30, s[40:43], s99 offen offset:2176 lds
  buffer_load_dwordx4 v31, s[40:43], s99 offen offset:3264 lds
  v_mfma_f32_16x16x32_bf16 v[96:99], a[64:67], a[0:3], 0
  v_mfma_f32_16x16x32_bf16 v[96:99], a[68:71], a[4:7], v[96:99]
  v_mfma_f32_16x16x32_bf16 v[96:99], a[72:75], a[8:11], v[96:99]
  v_mfma_f32_16x16x32_bf16 v[96:99], a[76:79], a[12:15], v[96:99]
  v_mfma_f32_16x16x32_bf16 v[100:103], a[80:83], a[0:3], 0
  v_mfma_f32_16x16x32_bf16 v[100:103], a[84:87], a[4:7], v[100:103]
  v_mfma_f32_16x16x32_bf16 v[100:103], a[88:91], a[8:11], v[100:103]
  v_mfma_f32_16x16x32_bf16 v[100:103], a[92:95], a[12:15], v[100:103]
  v_mfma_f32_16x16x32_bf16 v[104:107], a[64:67], a[16:19], 0
  v_mfma_f32_16x16x32_bf16 v[104:107], a[68:71], a[20:23], v[104:107]
  v_mfma_f32_16x16x32_bf16 v[104:107], a[72:75], a[24:27], v[104:107]
  v_mfma_f32_16x16x32_bf16 v[104:107], a[76:79], a[28:31], v[104:107]
  v_mfma_f32_16x16x32_bf16 v[108:111], a[80:83], a[16:19], 0
  v_mfma_f32_16x16x32_bf16 v[108:111], a[84:87], a[20:23], v[108:111]
  v_mfma_f32_16x16x32_bf16 v[108:111], a[88:91], a[24:27], v[108:111]
  v_mfma_f32_16x16x32_bf16 v[108:111], a[92:95], a[28:31], v[108:111]
  v_mfma_f32_16x16x32_bf16 v[112:115], a[64:67], a[32:35], 0
  v_mfma_f32_16x16x32_bf16 v[112:115], a[68:71], a[36:39], v[112:115]
  v_mfma_f32_16x16x32_bf16 v[112:115], a[72:75], a[40:43], v[112:115]
  v_mfma_f32_16x16x32_bf16 v[112:115], a[76:79], a[44:47], v[112:115]
  v_mfma_f32_16x16x32_bf16 v[116:119], a[80:83], a[32:35], 0
  v_mfma_f32_16x16x32_bf16 v[116:119], a[84:87], a[36:39], v[116:119]
  v_mfma_f32_16x16x32_bf16 v[116:119], a[88:91], a[40:43], v[116:119]
  v_mfma_f32_16x16x32_bf16 v[116:119], a[92:95], a[44:47], v[116:119]
  v_mfma_f32_16x16x32_bf16 v[120:123], a[64:67], a[48:51], 0
  v_mfma_f32_16x16x32_bf16 v[120:123], a[68:71], a[52:55], v[120:123]
  v_mfma_f32_16x16x32_bf16 v[120:123], a[72:75], a[56:59], v[120:123]
  v_mfma_f32_16x16x32_bf16 v[120:123], a[76:79], a[60:63], v[120:123]
  v_mfma_f32_16x16x32_bf16 v[124:127], a[80:83], a[48:51], 0
  v_mfma_f32_16x16x32_bf16 v[124:127], a[84:87], a[52:55], v[124:127]
  v_mfma_f32_16x16x32_bf16 v[124:127], a[88:91], a[56:59], v[124:127]
  v_mfma_f32_16x16x32_bf16 v[124:127], a[92:95], a[60:63], v[124:127]
  s_lshl_b32 s58, s52, 5
  s_sub_u32 s58, s47, s58
  v_mov_b32 v5, 0xff800000
  v_add_u32 v4, 0, v23
  v_cmp_le_u32 vcc, s58, v4
  s_nop 1
  v_cndmask_b32 v96, v96, v5, vcc
  v_cndmask_b32 v104, v104, v5, vcc
  v_cndmask_b32 v112, v112, v5, vcc
  v_cndmask_b32 v120, v120, v5, vcc
  v_add_u32 v4, 4, v23
  v_cmp_le_u32 vcc, s58, v4
  s_nop 1
  v_cndmask_b32 v97, v97, v5, vcc
  v_cndmask_b32 v105, v105, v5, vcc
  v_cndmask_b32 v113, v113, v5, vcc
  v_cndmask_b32 v121, v121, v5, vcc
  v_add_u32 v4, 8, v23
  v_cmp_le_u32 vcc, s58, v4
  s_nop 1
  v_cndmask_b32 v98, v98, v5, vcc
  v_cndmask_b32 v106, v106, v5, vcc
  v_cndmask_b32 v114, v114, v5, vcc
  v_cndmask_b32 v122, v122, v5, vcc
  v_add_u32 v4, 12, v23
  v_cmp_le_u32 vcc, s58, v4
  s_nop 1
  v_cndmask_b32 v99, v99, v5, vcc
  v_cndmask_b32 v107, v107, v5, vcc
  v_cndmask_b32 v115, v115, v5, vcc
  v_cndmask_b32 v123, v123, v5, vcc
  v_add_u32 v4, 2, v23
  v_cmp_le_u32 vcc, s58, v4
  s_nop 1
  v_cndmask_b32 v100, v100, v5, vcc
  v_cndmask_b32 v108, v108, v5, vcc
  v_cndmask_b32 v116, v116, v5, vcc
  v_cndmask_b32 v124, v124, v5, vcc
  v_add_u32 v4, 6, v23
  v_cmp_le_u32 vcc, s58, v4
  s_nop 1
  v_cndmask_b32 v101, v101, v5, vcc
  v_cndmask_b32 v109, v109, v5, vcc
  v_cndmask_b32 v117, v117, v5, vcc
  v_cndmask_b32 v125, v125, v5, vcc
  v_add_u32 v4, 10, v23
  v_cmp_le_u32 vcc, s58, v4
  s_nop 1
  v_cndmask_b32 v102, v102, v5, vcc
  v_cndmask_b32 v110, v110, v5, vcc
  v_cndmask_b32 v118, v118, v5, vcc
  v_cndmask_b32 v126, v126, v5, vcc
  v_add_u32 v4, 14, v23
  v_cmp_le_u32 vcc, s58, v4
  s_nop 1
  v_cndmask_b32 v103, v103, v5, vcc
  v_cndmask_b32 v111, v111, v5, vcc
  v_cndmask_b32 v119, v119, v5, vcc
  v_cndmask_b32 v127, v127, v5, vcc
  v_max3_f32 v1, v96, v97, v98
  v_max3_f32 v2, v99, v100, v101
  v_max3_f32 v1, v1, v102, v103
  v_max_f32 v1, v1, v2
  v_mov_b32 v2, v1
  s_nop 1
  v_permlane32_swap_b32 v1, v2
  v_max_f32 v1, v1, v2
  v_mov_b32 v2, v1
  s_nop 1
  v_permlane16_swap_b32 v1, v2
  v_max_f32 v1, v1, v2
  v_max_f32 v1, v1, v8
  v_sub_f32 v2, v8, v1
  v_exp_f32 v2, v2
  v_mov_b32 v8, v1
  v_sub_f32 v96, v96, v1
  v_sub_f32 v97, v97, v1
  v_sub_f32 v98, v98, v1
  v_sub_f32 v99, v99, v1
  v_sub_f32 v100, v100, v1
  v_sub_f32 v101, v101, v1
  v_sub_f32 v102, v102, v1
  v_sub_f32 v103, v103, v1
  v_exp_f32 v96, v96
  v_exp_f32 v97, v97
  v_exp_f32 v98, v98
  v_exp_f32 v99, v99
  v_exp_f32 v100, v100
  v_exp_f32 v101, v101
  v_exp_f32 v102, v102
  v_exp_f32 v103, v103
  v_mul_f32 v12, v12, v2
  v_mul_f32 v128, v128, v2
  v_mul_f32 v129, v129, v2
  v_mul_f32 v130, v130, v2
  v_mul_f32 v131, v131, v2
  v_mul_f32 v132, v132, v2
  v_mul_f32 v133, v133, v2
  v_mul_f32 v134, v134, v2
  v_mul_f32 v135, v135, v2
  v_mul_f32 v136, v136, v2
  v_mul_f32 v137, v137, v2
  v_mul_f32 v138, v138, v2
  v_mul_f32 v139, v139, v2
  v_mul_f32 v140, v140, v2
  v_mul_f32 v141, v141, v2
  v_mul_f32 v142, v142, v2
  v_mul_f32 v143, v143, v2
  v_mul_f32 v144, v144, v2
  v_mul_f32 v145, v145, v2
  v_mul_f32 v146, v146, v2
  v_mul_f32 v147, v147, v2
  v_mul_f32 v148, v148, v2
  v_mul_f32 v149, v149, v2
  v_mul_f32 v150, v150, v2
  v_mul_f32 v151, v151, v2
  v_mul_f32 v152, v152, v2
  v_mul_f32 v153, v153, v2
  v_mul_f32 v154, v154, v2
  v_mul_f32 v155, v155, v2
  v_mul_f32 v156, v156, v2
  v_mul_f32 v157, v157, v2
  v_mul_f32 v158, v158, v2
  v_mul_f32 v159, v159, v2
  v_cvt_pk_bf16_f32 v64, v96, v97
  v_cvt_pk_bf16_f32 v65, v98, v99
  v_cvt_pk_bf16_f32 v66, v100, v101
  v_cvt_pk_bf16_f32 v67, v102, v103
  v_lshlrev_b32 v3, 16, v64
  v_and_b32 v4, 0xffff0000, v64
  v_add_f32 v12, v12, v3
  v_add_f32 v12, v12, v4
  v_lshlrev_b32 v3, 16, v65
  v_and_b32 v4, 0xffff0000, v65
  v_add_f32 v12, v12, v3
  v_add_f32 v12, v12, v4
  v_lshlrev_b32 v3, 16, v66
  v_and_b32 v4, 0xffff0000, v66
  v_add_f32 v12, v12, v3
  v_add_f32 v12, v12, v4
  v_lshlrev_b32 v3, 16, v67
  v_and_b32 v4, 0xffff0000, v67
  v_add_f32 v12, v12, v3
  v_add_f32 v12, v12, v4
  v_max3_f32 v1, v104, v105, v106
  v_max3_f32 v2, v107, v108, v109
  v_max3_f32 v1, v1, v110, v111
  v_max_f32 v1, v1, v2
  v_mov_b32 v2, v1
  s_nop 1
  v_permlane32_swap_b32 v1, v2
  v_max_f32 v1, v1, v2
  v_mov_b32 v2, v1
  s_nop 1
  v_permlane16_swap_b32 v1, v2
  v_max_f32 v1, v1, v2
  v_max_f32 v1, v1, v9
  v_sub_f32 v2, v9, v1
  v_exp_f32 v2, v2
  v_mov_b32 v9, v1
  v_sub_f32 v104, v104, v1
  v_sub_f32 v105, v105, v1
  v_sub_f32 v106, v106, v1
  v_sub_f32 v107, v107, v1
  v_sub_f32 v108, v108, v1
  v_sub_f32 v109, v109, v1
  v_sub_f32 v110, v110, v1
  v_sub_f32 v111, v111, v1
  v_exp_f32 v104, v104
  v_exp_f32 v105, v105
  v_exp_f32 v106, v106
  v_exp_f32 v107, v107
  v_exp_f32 v108, v108
  v_exp_f32 v109, v109
  v_exp_f32 v110, v110
  v_exp_f32 v111, v111
  v_mul_f32 v13, v13, v2
  v_mul_f32 v160, v160, v2
  v_mul_f32 v161, v161, v2
  v_mul_f32 v162, v162, v2
  v_mul_f32 v163, v163, v2
  v_mul_f32 v164, v164, v2
  v_mul_f32 v165, v165, v2
  v_mul_f32 v166, v166, v2
  v_mul_f32 v167, v167, v2
  v_mul_f32 v168, v168, v2
  v_mul_f32 v169, v169, v2
  v_mul_f32 v170, v170, v2
  v_mul_f32 v171, v171, v2
  v_mul_f32 v172, v172, v2
  v_mul_f32 v173, v173, v2
  v_mul_f32 v174, v174, v2
  v_mul_f32 v175, v175, v2
  v_mul_f32 v176, v176, v2
  v_mul_f32 v177, v177, v2
  v_mul_f32 v178, v178, v2
  v_mul_f32 v179, v179, v2
  v_mul_f32 v180, v180, v2
  v_mul_f32 v181, v181, v2
  v_mul_f32 v182, v182, v2
  v_mul_f32 v183, v183, v2
  v_mul_f32 v184, v184, v2
  v_mul_f32 v185, v185, v2
  v_mul_f32 v186, v186, v2
  v_mul_f32 v187, v187, v2
  v_mul_f32 v188, v188, v2
  v_mul_f32 v189, v189, v2
  v_mul_f32 v190, v190, v2
  v_mul_f32 v191, v191, v2
  v_cvt_pk_bf16_f32 v68, v104, v105
  v_cvt_pk_bf16_f32 v69, v106, v107
  v_cvt_pk_bf16_f32 v70, v108, v109
  v_cvt_pk_bf16_f32 v71, v110, v111
  v_lshlrev_b32 v3, 16, v68
  v_and_b32 v4, 0xffff0000, v68
  v_add_f32 v13, v13, v3
  v_add_f32 v13, v13, v4
  v_lshlrev_b32 v3, 16, v69
  v_and_b32 v4, 0xffff0000, v69
  v_add_f32 v13, v13, v3
  v_add_f32 v13, v13, v4
  v_lshlrev_b32 v3, 16, v70
  v_and_b32 v4, 0xffff0000, v70
  v_add_f32 v13, v13, v3
  v_add_f32 v13, v13, v4
  v_lshlrev_b32 v3, 16, v71
  v_and_b32 v4, 0xffff0000, v71
  v_add_f32 v13, v13, v3
  v_add_f32 v13, v13, v4
  v_max3_f32 v1, v112, v113, v114
  v_max3_f32 v2, v115, v116, v117
  v_max3_f32 v1, v1, v118, v119
  v_max_f32 v1, v1, v2
  v_mov_b32 v2, v1
  s_nop 1
  v_permlane32_swap_b32 v1, v2
  v_max_f32 v1, v1, v2
  v_mov_b32 v2, v1
  s_nop 1
  v_permlane16_swap_b32 v1, v2
  v_max_f32 v1, v1, v2
  v_max_f32 v1, v1, v10
  v_sub_f32 v2, v10, v1
  v_exp_f32 v2, v2
  v_mov_b32 v10, v1
  v_sub_f32 v112, v112, v1
  v_sub_f32 v113, v113, v1
  v_sub_f32 v114, v114, v1
  v_sub_f32 v115, v115, v1
  v_sub_f32 v116, v116, v1
  v_sub_f32 v117, v117, v1
  v_sub_f32 v118, v118, v1
  v_sub_f32 v119, v119, v1
  v_exp_f32 v112, v112
  v_exp_f32 v113, v113
  v_exp_f32 v114, v114
  v_exp_f32 v115, v115
  v_exp_f32 v116, v116
  v_exp_f32 v117, v117
  v_exp_f32 v118, v118
  v_exp_f32 v119, v119
  v_mul_f32 v14, v14, v2
  v_mul_f32 v192, v192, v2
  v_mul_f32 v193, v193, v2
  v_mul_f32 v194, v194, v2
  v_mul_f32 v195, v195, v2
  v_mul_f32 v196, v196, v2
  v_mul_f32 v197, v197, v2
  v_mul_f32 v198, v198, v2
  v_mul_f32 v199, v199, v2
  v_mul_f32 v200, v200, v2
  v_mul_f32 v201, v201, v2
  v_mul_f32 v202, v202, v2
  v_mul_f32 v203, v203, v2
  v_mul_f32 v204, v204, v2
  v_mul_f32 v205, v205, v2
  v_mul_f32 v206, v206, v2
  v_mul_f32 v207, v207, v2
  v_mul_f32 v208, v208, v2
  v_mul_f32 v209, v209, v2
  v_mul_f32 v210, v210, v2
  v_mul_f32 v211, v211, v2
  v_mul_f32 v212, v212, v2
  v_mul_f32 v213, v213, v2
  v_mul_f32 v214, v214, v2
  v_mul_f32 v215, v215, v2
  v_mul_f32 v216, v216, v2
  v_mul_f32 v217, v217, v2
  v_mul_f32 v218, v218, v2
  v_mul_f32 v219, v219, v2
  v_mul_f32 v220, v220, v2
  v_mul_f32 v221, v221, v2
  v_mul_f32 v222, v222, v2
  v_mul_f32 v223, v223, v2
  v_cvt_pk_bf16_f32 v72, v112, v113
  v_cvt_pk_bf16_f32 v73, v114, v115
  v_cvt_pk_bf16_f32 v74, v116, v117
  v_cvt_pk_bf16_f32 v75, v118, v119
  v_lshlrev_b32 v3, 16, v72
  v_and_b32 v4, 0xffff0000, v72
  v_add_f32 v14, v14, v3
  v_add_f32 v14, v14, v4
  v_lshlrev_b32 v3, 16, v73
  v_and_b32 v4, 0xffff0000, v73
  v_add_f32 v14, v14, v3
  v_add_f32 v14, v14, v4
  v_lshlrev_b32 v3, 16, v74
  v_and_b32 v4, 0xffff0000, v74
  v_add_f32 v14, v14, v3
  v_add_f32 v14, v14, v4
  v_lshlrev_b32 v3, 16, v75
  v_and_b32 v4, 0xffff0000, v75
  v_add_f32 v14, v14, v3
  v_add_f32 v14, v14, v4
  v_max3_f32 v1, v120, v121, v122
  v_max3_f32 v2, v123, v124, v125
  v_max3_f32 v1, v1, v126, v127
  v_max_f32 v1, v1, v2
  v_mov_b32 v2, v1
  s_nop 1
  v_permlane32_swap_b32 v1, v2
  v_max_f32 v1, v1, v2
  v_mov_b32 v2, v1
  s_nop 1
  v_permlane16_swap_b32 v1, v2
  v_max_f32 v1, v1, v2
  v_max_f32 v1, v1, v11
  v_sub_f32 v2, v11, v1
  v_exp_f32 v2, v2
  v_mov_b32 v11, v1
  v_sub_f32 v120, v120, v1
  v_sub_f32 v121, v121, v1
  v_sub_f32 v122, v122, v1
  v_sub_f32 v123, v123, v1
  v_sub_f32 v124, v124, v1
  v_sub_f32 v125, v125, v1
  v_sub_f32 v126, v126, v1
  v_sub_f32 v127, v127, v1
  v_exp_f32 v120, v120
  v_exp_f32 v121, v121
  v_exp_f32 v122, v122
  v_exp_f32 v123, v123
  v_exp_f32 v124, v124
  v_exp_f32 v125, v125
  v_exp_f32 v126, v126
  v_exp_f32 v127, v127
  v_mul_f32 v15, v15, v2
  v_mul_f32 v224, v224, v2
  v_mul_f32 v225, v225, v2
  v_mul_f32 v226, v226, v2
  v_mul_f32 v227, v227, v2
  v_mul_f32 v228, v228, v2
  v_mul_f32 v229, v229, v2
  v_mul_f32 v230, v230, v2
  v_mul_f32 v231, v231, v2
  v_mul_f32 v232, v232, v2
  v_mul_f32 v233, v233, v2
  v_mul_f32 v234, v234, v2
  v_mul_f32 v235, v235, v2
  v_mul_f32 v236, v236, v2
  v_mul_f32 v237, v237, v2
  v_mul_f32 v238, v238, v2
  v_mul_f32 v239, v239, v2
  v_mul_f32 v240, v240, v2
  v_mul_f32 v241, v241, v2
  v_mul_f32 v242, v242, v2
  v_mul_f32 v243, v243, v2
  v_mul_f32 v244, v244, v2
  v_mul_f32 v245, v245, v2
  v_mul_f32 v246, v246, v2
  v_mul_f32 v247, v247, v2
  v_mul_f32 v248, v248, v2
  v_mul_f32 v249, v249, v2
  v_mul_f32 v250, v250, v2
  v_mul_f32 v251, v251, v2
  v_mul_f32 v252, v252, v2
  v_mul_f32 v253, v253, v2
  v_mul_f32 v254, v254, v2
  v_mul_f32 v255, v255, v2
  v_cvt_pk_bf16_f32 v76, v120, v121
  v_cvt_pk_bf16_f32 v77, v122, v123
  v_cvt_pk_bf16_f32 v78, v124, v125
  v_cvt_pk_bf16_f32 v79, v126, v127
  v_lshlrev_b32 v3, 16, v76
  v_and_b32 v4, 0xffff0000, v76
  v_add_f32 v15, v15, v3
  v_add_f32 v15, v15, v4
  v_lshlrev_b32 v3, 16, v77
  v_and_b32 v4, 0xffff0000, v77
  v_add_f32 v15, v15, v3
  v_add_f32 v15, v15, v4
  v_lshlrev_b32 v3, 16, v78
  v_and_b32 v4, 0xffff0000, v78
  v_add_f32 v15, v15, v3
  v_add_f32 v15, v15, v4
  v_lshlrev_b32 v3, 16, v79
  v_and_b32 v4, 0xffff0000, v79
  v_add_f32 v15, v15, v3
  v_add_f32 v15, v15, v4
  s_waitcnt vmcnt(0)
  ds_read_b64_tr_b16 a[128:129], v33 offset:0
  ds_read_b64_tr_b16 a[130:131], v33 offset:512
  ds_read_b64_tr_b16 a[132:133], v33 offset:8
  ds_read_b64_tr_b16 a[134:135], v33 offset:520
  ds_read_b64_tr_b16 a[136:137], v33 offset:64
  ds_read_b64_tr_b16 a[138:139], v33 offset:576
  ds_read_b64_tr_b16 a[140:141], v33 offset:72
  ds_read_b64_tr_b16 a[142:143], v33 offset:584
  s_waitcnt lgkmcnt(0)
  ds_read_b64_tr_b16 a[144:145], v33 offset:128
  ds_read_b64_tr_b16 a[146:147], v33 offset:640
  ds_read_b64_tr_b16 a[148:149], v33 offset:136
  ds_read_b64_tr_b16 a[150:151], v33 offset:648
  ds_read_b64_tr_b16 a[152:153], v33 offset:192
  ds_read_b64_tr_b16 a[154:155], v33 offset:704
  ds_read_b64_tr_b16 a[156:157], v33 offset:200
  ds_read_b64_tr_b16 a[158:159], v33 offset:712
  s_waitcnt lgkmcnt(0)
  v_mfma_f32_16x16x32_bf16 v[128:131], a[128:131], v[64:67], v[128:131]
  v_mfma_f32_16x16x32_bf16 v[132:135], a[132:135], v[64:67], v[132:135]
  v_mfma_f32_16x16x32_bf16 v[136:139], a[136:139], v[64:67], v[136:139]
  v_mfma_f32_16x16x32_bf16 v[140:143], a[140:143], v[64:67], v[140:143]
  v_mfma_f32_16x16x32_bf16 v[144:147], a[144:147], v[64:67], v[144:147]
  v_mfma_f32_16x16x32_bf16 v[148:151], a[148:151], v[64:67], v[148:151]
  v_mfma_f32_16x16x32_bf16 v[152:155], a[152:155], v[64:67], v[152:155]
  v_mfma_f32_16x16x32_bf16 v[156:159], a[156:159], v[64:67], v[156:159]
  v_mfma_f32_16x16x32_bf16 v[160:163], a[128:131], v[68:71], v[160:163]
  v_mfma_f32_16x16x32_bf16 v[164:167], a[132:135], v[68:71], v[164:167]
  v_mfma_f32_16x16x32_bf16 v[168:171], a[136:139], v[68:71], v[168:171]
  v_mfma_f32_16x16x32_bf16 v[172:175], a[140:143], v[68:71], v[172:175]
  v_mfma_f32_16x16x32_bf16 v[176:179], a[144:147], v[68:71], v[176:179]
  v_mfma_f32_16x16x32_bf16 v[180:183], a[148:151], v[68:71], v[180:183]
  v_mfma_f32_16x16x32_bf16 v[184:187], a[152:155], v[68:71], v[184:187]
  v_mfma_f32_16x16x32_bf16 v[188:191], a[156:159], v[68:71], v[188:191]
  v_mfma_f32_16x16x32_bf16 v[192:195], a[128:131], v[72:75], v[192:195]
  v_mfma_f32_16x16x32_bf16 v[196:199], a[132:135], v[72:75], v[196:199]
  v_mfma_f32_16x16x32_bf16 v[200:203], a[136:139], v[72:75], v[200:203]
  v_mfma_f32_16x16x32_bf16 v[204:207], a[140:143], v[72:75], v[204:207]
  v_mfma_f32_16x16x32_bf16 v[208:211], a[144:147], v[72:75], v[208:211]
  v_mfma_f32_16x16x32_bf16 v[212:215], a[148:151], v[72:75], v[212:215]
  v_mfma_f32_16x16x32_bf16 v[216:219], a[152:155], v[72:75], v[216:219]
  v_mfma_f32_16x16x32_bf16 v[220:223], a[156:159], v[72:75], v[220:223]
  v_mfma_f32_16x16x32_bf16 v[224:227], a[128:131], v[76:79], v[224:227]
  v_mfma_f32_16x16x32_bf16 v[228:231], a[132:135], v[76:79], v[228:231]
  v_mfma_f32_16x16x32_bf16 v[232:235], a[136:139], v[76:79], v[232:235]
  v_mfma_f32_16x16x32_bf16 v[236:239], a[140:143], v[76:79], v[236:239]
  v_mfma_f32_16x16x32_bf16 v[240:243], a[144:147], v[76:79], v[240:243]
  v_mfma_f32_16x16x32_bf16 v[244:247], a[148:151], v[76:79], v[244:247]
  v_mfma_f32_16x16x32_bf16 v[248:251], a[152:155], v[76:79], v[248:251]
  v_mfma_f32_16x16x32_bf16 v[252:255], a[156:159], v[76:79], v[252:255]
  s_nop 7
  s_add_u32 s52, s52, 1
  s_cmp_le_u32 s52, s48
  s_cbranch_scc1 L_sloop
  v_mov_b32 v5, v12
  s_nop 1
  v_permlane32_swap_b32 v5, v12
  v_add_f32 v12, v12, v5
  v_mov_b32 v5, v12
  s_nop 1
  v_permlane16_swap_b32 v5, v12
  v_add_f32 v12, v12, v5
  v_mov_b32 v5, v13
  s_nop 1
  v_permlane32_swap_b32 v5, v13
  v_add_f32 v13, v13, v5
  v_mov_b32 v5, v13
  s_nop 1
  v_permlane16_swap_b32 v5, v13
  v_add_f32 v13, v13, v5
  v_mov_b32 v5, v14
  s_nop 1
  v_permlane32_swap_b32 v5, v14
  v_add_f32 v14, v14, v5
  v_mov_b32 v5, v14
  s_nop 1
  v_permlane16_swap_b32 v5, v14
  v_add_f32 v14, v14, v5
  v_mov_b32 v5, v15
  s_nop 1
  v_permlane32_swap_b32 v5, v15
  v_add_f32 v15, v15, v5
  v_mov_b32 v5, v15
  s_nop 1
  v_permlane16_swap_b32 v5, v15
  v_add_f32 v15, v15, v5
  v_rcp_f32 v2, v12
  v_rcp_f32 v3, v13
  v_rcp_f32 v4, v14
  v_rcp_f32 v5, v15
  v_pk_mul_f32 v[128:129], v[128:129], v[2:3] op_sel_hi:[1,0]
  v_pk_mul_f32 v[130:131], v[130:131], v[2:3] op_sel_hi:[1,0]
  v_pk_mul_f32 v[132:133], v[132:133], v[2:3] op_sel_hi:[1,0]
  v_pk_mul_f32 v[134:135], v[134:135], v[2:3] op_sel_hi:[1,0]
  v_cvt_pk_bf16_f32 v128, v128, v129
  v_cvt_pk_bf16_f32 v129, v130, v131
  v_cvt_pk_bf16_f32 v130, v132, v133
  v_cvt_pk_bf16_f32 v131, v134, v135
  buffer_store_dwordx4 v[128:131], v24, s[28:31], s60 offen offset:0 sc1
  v_pk_mul_f32 v[136:137], v[136:137], v[2:3] op_sel_hi:[1,0]
  v_pk_mul_f32 v[138:139], v[138:139], v[2:3] op_sel_hi:[1,0]
  v_pk_mul_f32 v[140:141], v[140:141], v[2:3] op_sel_hi:[1,0]
  v_pk_mul_f32 v[142:143], v[142:143], v[2:3] op_sel_hi:[1,0]
  v_cvt_pk_bf16_f32 v136, v136, v137
  v_cvt_pk_bf16_f32 v137, v138, v139
  v_cvt_pk_bf16_f32 v138, v140, v141
  v_cvt_pk_bf16_f32 v139, v142, v143
  buffer_store_dwordx4 v[136:139], v24, s[28:31], s60 offen offset:64 sc1
  v_pk_mul_f32 v[144:145], v[144:145], v[2:3] op_sel_hi:[1,0]
  v_pk_mul_f32 v[146:147], v[146:147], v[2:3] op_sel_hi:[1,0]
  v_pk_mul_f32 v[148:149], v[148:149], v[2:3] op_sel_hi:[1,0]
  v_pk_mul_f32 v[150:151], v[150:151], v[2:3] op_sel_hi:[1,0]
  v_cvt_pk_bf16_f32 v144, v144, v145
  v_cvt_pk_bf16_f32 v145, v146, v147
  v_cvt_pk_bf16_f32 v146, v148, v149
  v_cvt_pk_bf16_f32 v147, v150, v151
  buffer_store_dwordx4 v[144:147], v24, s[28:31], s60 offen offset:128 sc1
  v_pk_mul_f32 v[152:153], v[152:153], v[2:3] op_sel_hi:[1,0]
  v_pk_mul_f32 v[154:155], v[154:155], v[2:3] op_sel_hi:[1,0]
  v_pk_mul_f32 v[156:157], v[156:157], v[2:3] op_sel_hi:[1,0]
  v_pk_mul_f32 v[158:159], v[158:159], v[2:3] op_sel_hi:[1,0]
  v_cvt_pk_bf16_f32 v152, v152, v153
  v_cvt_pk_bf16_f32 v153, v154, v155
  v_cvt_pk_bf16_f32 v154, v156, v157
  v_cvt_pk_bf16_f32 v155, v158, v159
  buffer_store_dwordx4 v[152:155], v24, s[28:31], s60 offen offset:192 sc1
  v_pk_mul_f32 v[160:161], v[160:161], v[2:3] op_sel:[0,1] op_sel_hi:[1,1]
  v_pk_mul_f32 v[162:163], v[162:163], v[2:3] op_sel:[0,1] op_sel_hi:[1,1]
  v_pk_mul_f32 v[164:165], v[164:165], v[2:3] op_sel:[0,1] op_sel_hi:[1,1]
  v_pk_mul_f32 v[166:167], v[166:167], v[2:3] op_sel:[0,1] op_sel_hi:[1,1]
  v_cvt_pk_bf16_f32 v160, v160, v161
  v_cvt_pk_bf16_f32 v161, v162, v163
  v_cvt_pk_bf16_f32 v162, v164, v165
  v_cvt_pk_bf16_f32 v163, v166, v167
  buffer_store_dwordx4 v[160:163], v24, s[28:31], s61 offen offset:0 sc1
  v_pk_mul_f32 v[168:169], v[168:169], v[2:3] op_sel:[0,1] op_sel_hi:[1,1]
  v_pk_mul_f32 v[170:171], v[170:171], v[2:3] op_sel:[0,1] op_sel_hi:[1,1]
  v_pk_mul_f32 v[172:173], v[172:173], v[2:3] op_sel:[0,1] op_sel_hi:[1,1]
  v_pk_mul_f32 v[174:175], v[174:175], v[2:3] op_sel:[0,1] op_sel_hi:[1,1]
  v_cvt_pk_bf16_f32 v168, v168, v169
  v_cvt_pk_bf16_f32 v169, v170, v171
  v_cvt_pk_bf16_f32 v170, v172, v173
  v_cvt_pk_bf16_f32 v171, v174, v175
  buffer_store_dwordx4 v[168:171], v24, s[28:31], s61 offen offset:64 sc1
  v_pk_mul_f32 v[176:177], v[176:177], v[2:3] op_sel:[0,1] op_sel_hi:[1,1]
  v_pk_mul_f32 v[178:179], v[178:179], v[2:3] op_sel:[0,1] op_sel_hi:[1,1]
  v_pk_mul_f32 v[180:181], v[180:181], v[2:3] op_sel:[0,1] op_sel_hi:[1,1]
  v_pk_mul_f32 v[182:183], v[182:183], v[2:3] op_sel:[0,1] op_sel_hi:[1,1]
  v_cvt_pk_bf16_f32 v176, v176, v177
  v_cvt_pk_bf16_f32 v177, v178, v179
  v_cvt_pk_bf16_f32 v178, v180, v181
  v_cvt_pk_bf16_f32 v179, v182, v183
  buffer_store_dwordx4 v[176:179], v24, s[28:31], s61 offen offset:128 sc1
  v_pk_mul_f32 v[184:185], v[184:185], v[2:3] op_sel:[0,1] op_sel_hi:[1,1]
  v_pk_mul_f32 v[186:187], v[186:187], v[2:3] op_sel:[0,1] op_sel_hi:[1,1]
  v_pk_mul_f32 v[188:189], v[188:189], v[2:3] op_sel:[0,1] op_sel_hi:[1,1]
  v_pk_mul_f32 v[190:191], v[190:191], v[2:3] op_sel:[0,1] op_sel_hi:[1,1]
  v_cvt_pk_bf16_f32 v184, v184, v185
  v_cvt_pk_bf16_f32 v185, v186, v187
  v_cvt_pk_bf16_f32 v186, v188, v189
  v_cvt_pk_bf16_f32 v187, v190, v191
  buffer_store_dwordx4 v[184:187], v24, s[28:31], s61 offen offset:192 sc1
  v_pk_mul_f32 v[192:193], v[192:193], v[4:5] op_sel_hi:[1,0]
  v_pk_mul_f32 v[194:195], v[194:195], v[4:5] op_sel_hi:[1,0]
  v_pk_mul_f32 v[196:197], v[196:197], v[4:5] op_sel_hi:[1,0]
  v_pk_mul_f32 v[198:199], v[198:199], v[4:5] op_sel_hi:[1,0]
  v_cvt_pk_bf16_f32 v192, v192, v193
  v_cvt_pk_bf16_f32 v193, v194, v195
  v_cvt_pk_bf16_f32 v194, v196, v197
  v_cvt_pk_bf16_f32 v195, v198, v199
  buffer_store_dwordx4 v[192:195], v24, s[28:31], s62 offen offset:0 sc1
  v_pk_mul_f32 v[200:201], v[200:201], v[4:5] op_sel_hi:[1,0]
  v_pk_mul_f32 v[202:203], v[202:203], v[4:5] op_sel_hi:[1,0]
  v_pk_mul_f32 v[204:205], v[204:205], v[4:5] op_sel_hi:[1,0]
  v_pk_mul_f32 v[206:207], v[206:207], v[4:5] op_sel_hi:[1,0]
  v_cvt_pk_bf16_f32 v200, v200, v201
  v_cvt_pk_bf16_f32 v201, v202, v203
  v_cvt_pk_bf16_f32 v202, v204, v205
  v_cvt_pk_bf16_f32 v203, v206, v207
  buffer_store_dwordx4 v[200:203], v24, s[28:31], s62 offen offset:64 sc1
  v_pk_mul_f32 v[208:209], v[208:209], v[4:5] op_sel_hi:[1,0]
  v_pk_mul_f32 v[210:211], v[210:211], v[4:5] op_sel_hi:[1,0]
  v_pk_mul_f32 v[212:213], v[212:213], v[4:5] op_sel_hi:[1,0]
  v_pk_mul_f32 v[214:215], v[214:215], v[4:5] op_sel_hi:[1,0]
  v_cvt_pk_bf16_f32 v208, v208, v209
  v_cvt_pk_bf16_f32 v209, v210, v211
  v_cvt_pk_bf16_f32 v210, v212, v213
  v_cvt_pk_bf16_f32 v211, v214, v215
  buffer_store_dwordx4 v[208:211], v24, s[28:31], s62 offen offset:128 sc1
  v_pk_mul_f32 v[216:217], v[216:217], v[4:5] op_sel_hi:[1,0]
  v_pk_mul_f32 v[218:219], v[218:219], v[4:5] op_sel_hi:[1,0]
  v_pk_mul_f32 v[220:221], v[220:221], v[4:5] op_sel_hi:[1,0]
  v_pk_mul_f32 v[222:223], v[222:223], v[4:5] op_sel_hi:[1,0]
  v_cvt_pk_bf16_f32 v216, v216, v217
  v_cvt_pk_bf16_f32 v217, v218, v219
  v_cvt_pk_bf16_f32 v218, v220, v221
  v_cvt_pk_bf16_f32 v219, v222, v223
  buffer_store_dwordx4 v[216:219], v24, s[28:31], s62 offen offset:192 sc1
  v_pk_mul_f32 v[224:225], v[224:225], v[4:5] op_sel:[0,1] op_sel_hi:[1,1]
  v_pk_mul_f32 v[226:227], v[226:227], v[4:5] op_sel:[0,1] op_sel_hi:[1,1]
  v_pk_mul_f32 v[228:229], v[228:229], v[4:5] op_sel:[0,1] op_sel_hi:[1,1]
  v_pk_mul_f32 v[230:231], v[230:231], v[4:5] op_sel:[0,1] op_sel_hi:[1,1]
  v_cvt_pk_bf16_f32 v224, v224, v225
  v_cvt_pk_bf16_f32 v225, v226, v227
  v_cvt_pk_bf16_f32 v226, v228, v229
  v_cvt_pk_bf16_f32 v227, v230, v231
  buffer_store_dwordx4 v[224:227], v24, s[28:31], s63 offen offset:0 sc1
  v_pk_mul_f32 v[232:233], v[232:233], v[4:5] op_sel:[0,1] op_sel_hi:[1,1]
  v_pk_mul_f32 v[234:235], v[234:235], v[4:5] op_sel:[0,1] op_sel_hi:[1,1]
  v_pk_mul_f32 v[236:237], v[236:237], v[4:5] op_sel:[0,1] op_sel_hi:[1,1]
  v_pk_mul_f32 v[238:239], v[238:239], v[4:5] op_sel:[0,1] op_sel_hi:[1,1]
  v_cvt_pk_bf16_f32 v232, v232, v233
  v_cvt_pk_bf16_f32 v233, v234, v235
  v_cvt_pk_bf16_f32 v234, v236, v237
  v_cvt_pk_bf16_f32 v235, v238, v239
  buffer_store_dwordx4 v[232:235], v24, s[28:31], s63 offen offset:64 sc1
  v_pk_mul_f32 v[240:241], v[240:241], v[4:5] op_sel:[0,1] op_sel_hi:[1,1]
  v_pk_mul_f32 v[242:243], v[242:243], v[4:5] op_sel:[0,1] op_sel_hi:[1,1]
  v_pk_mul_f32 v[244:245], v[244:245], v[4:5] op_sel:[0,1] op_sel_hi:[1,1]
  v_pk_mul_f32 v[246:247], v[246:247], v[4:5] op_sel:[0,1] op_sel_hi:[1,1]
  v_cvt_pk_bf16_f32 v240, v240, v241
  v_cvt_pk_bf16_f32 v241, v242, v243
  v_cvt_pk_bf16_f32 v242, v244, v245
  v_cvt_pk_bf16_f32 v243, v246, v247
  buffer_store_dwordx4 v[240:243], v24, s[28:31], s63 offen offset:128 sc1
  v_pk_mul_f32 v[248:249], v[248:249], v[4:5] op_sel:[0,1] op_sel_hi:[1,1]
  v_pk_mul_f32 v[250:251], v[250:251], v[4:5] op_sel:[0,1] op_sel_hi:[1,1]
  v_pk_mul_f32 v[252:253], v[252:253], v[4:5] op_sel:[0,1] op_sel_hi:[1,1]
  v_pk_mul_f32 v[254:255], v[254:255], v[4:5] op_sel:[0,1] op_sel_hi:[1,1]
  v_cvt_pk_bf16_f32 v248, v248, v249
  v_cvt_pk_bf16_f32 v249, v250, v251
  v_cvt_pk_bf16_f32 v250, v252, v253
  v_cvt_pk_bf16_f32 v251, v254, v255
  buffer_store_dwordx4 v[248:251], v24, s[28:31], s63 offen offset:192 sc1
  s_endpgm
L_codeend:
.section .rodata,"a"
.p2align 6
.amdhsa_kernel standalone__paged_block_table_kv_pagedattention__prompt_kernel
  .amdhsa_next_free_vgpr 512
  .amdhsa_next_free_sgpr 102
  .amdhsa_accum_offset 256
  .amdhsa_group_segment_fixed_size 0
  .amdhsa_kernarg_size 64
  .amdhsa_user_sgpr_count 2
  .amdhsa_user_sgpr_kernarg_segment_ptr 1
  .amdhsa_system_sgpr_workgroup_id_x 1
.end_amdhsa_kernel
```
